```python
import torch

def _softmax(x, axis=-1):
    return torch.softmax(x, dim=axis)
def _gelu(x):
    return torch.nn.functional.gelu(x, approximate="tanh")
def _silu(x):
    return torch.nn.functional.silu(x)
def _sigmoid(x):
    return torch.sigmoid(x)
def _layernorm(x, axis=-1, eps=1e-5):
    m = x.mean(dim=axis, keepdim=True)
    v = x.var(dim=axis, keepdim=True, unbiased=False)
    return (x - m) / torch.sqrt(v + eps)
def _scatter_add(tgt, idx, src, axis=0):
    return tgt.clone().index_add_(axis, idx, src)
def _segment_sum(src, seg, n):
    out = torch.zeros((n,) + src.shape[1:], dtype=src.dtype)
    return out.index_add_(0, seg, src)
def _pad(x, pw):
    flat = tuple(v for pair in reversed(pw) for v in pair)
    return torch.nn.functional.pad(x, flat)

kernel_name = 'parallel_sum__ssm_conv_s4__mixer_channel_mlp__prompt'

def setup_inputs():

    _w = (lambda a: (lambda t: t.to(torch.bfloat16) if t.is_floating_point() else t)(torch.as_tensor(a)))
    def _A_setup():
        B, L, D, N = 1, 2048, 512, 128
        A_re = -(lambda _x: torch.exp(torch.as_tensor(_x)))((lambda *s: torch.randn(*s, dtype=torch.bfloat16) * 3.2)(D, N))
        A_im = torch.pi * (lambda *s: torch.randn(*s, dtype=torch.bfloat16) * 0.05)(D, N)
        B_re = (lambda *s: torch.randn(*s, dtype=torch.bfloat16) * 0.1)(D, N)
        B_im = (lambda *s: torch.randn(*s, dtype=torch.bfloat16) * 0.1)(D, N)
        C_re = (lambda *s: torch.randn(*s, dtype=torch.bfloat16) * 0.1)(D, N)
        C_im = (lambda *s: torch.randn(*s, dtype=torch.bfloat16) * 0.1)(D, N)
        log_dt = (lambda *s: torch.randn(*s, dtype=torch.bfloat16) * 0.05)(D) * 0.5 - 4.0
        Dskip = (lambda *s: torch.randn(*s, dtype=torch.bfloat16) * 0.05)(D)
        return {
            "u": _w((lambda *s: torch.randn(*s, dtype=torch.bfloat16) * 0.05)(B, L, D)),
            "A_re": _w(A_re),
            "A_im": _w(A_im),
            "B_re": _w(B_re),
            "B_im": _w(B_im),
            "C_re": _w(C_re),
            "C_im": _w(C_im),
            "log_dt": _w(log_dt),
            "Dskip": _w(Dskip),
        }
    _A_in = _A_setup()

    def _B_setup():
        B, S, D, F = 1, 2048, 512, 1792
        return {
            "x": _w((lambda *s: torch.randn(*s, dtype=torch.bfloat16) * 0.05)(B, S, D)),
            "w1": _w((lambda *s: torch.randn(*s, dtype=torch.bfloat16) * 1.6)(D, F) * (D ** -0.5)),
            "b1": _w((lambda *s: torch.randn(*s, dtype=torch.bfloat16) * 0.8)(F)),
            "w2": _w((lambda *s: torch.randn(*s, dtype=torch.bfloat16) * 0.05)(F, D) * (F ** -0.5)),
            "b2": _w((lambda *s: torch.randn(*s, dtype=torch.bfloat16) * 0.05)(D)),
        }
    _B_in = _B_setup()

    return {
        "A_u": _A_in["u"],
        "A_A_re": _A_in["A_re"],
        "A_A_im": _A_in["A_im"],
        "A_B_re": _A_in["B_re"],
        "A_B_im": _A_in["B_im"],
        "A_C_re": _A_in["C_re"],
        "A_C_im": _A_in["C_im"],
        "A_log_dt": _A_in["log_dt"],
        "A_Dskip": _A_in["Dskip"],
        "B_x": _B_in["x"],
        "B_w1": _B_in["w1"],
        "B_b1": _B_in["b1"],
        "B_w2": _B_in["w2"],
        "B_b2": _B_in["b2"],
    }

def reference(A_u, A_A_re, A_A_im, A_B_re, A_B_im, A_C_re, A_C_im, A_log_dt, A_Dskip, B_x, B_w1, B_b1, B_w2, B_b2):
    def _A_ref(u, A_re, A_im, B_re, B_im, C_re, C_im, log_dt, Dskip):
        Bsz, L, D = u.shape
        dt = torch.exp(log_dt)[:, None]
        A = A_re + 1j * A_im
        Bc = B_re + 1j * B_im
        Cc = C_re + 1j * C_im
        logdA = dt * A
        dB = dt * Bc
        l = (lambda x, dt: x.to(dt))(torch.arange(L), A_re.dtype)
        P = torch.exp(logdA[:, :, None] * l[None, None, :])
        K = torch.einsum("dn,dnl,dn->dl", Cc, P, dB).real
        L2 = 2 * L
        Kp = _pad(K, ((0, 0), (0, L)))
        up = (lambda x, *d: x.permute(*d))(u, 0, 2, 1)
        up = _pad(up, ((0, 0), (0, 0), (0, L)))
        Kf = (lambda x, axes=(-2,-1): torch.fft.rfft2(x.float(), dim=axes))(Kp[:, None, :], axes=(-2, -1))
        Uf = (lambda x, axes=(-2,-1): torch.fft.rfft2(x.float(), dim=axes))(up[:, :, None, :], axes=(-2, -1))
        Yf = Uf * Kf[None, :, :, :]
        y = (lambda x, s, axes=(-2,-1): torch.fft.irfft2(x, s=s, dim=axes).to(torch.bfloat16))(Yf, (1, L2), axes=(-2, -1))[:, :, 0, :L]
        y = (lambda x, *d: x.permute(*d))(y, 0, 2, 1) + u * Dskip[None, None, :]
        return y

    def _B_ref(x, w1, b1, w2, b2):
        y = _layernorm(x, axis=-1)
        h = _gelu(torch.einsum("bsd,df->bsf", y, w1) + b1)
        return torch.einsum("bsf,fd->bsd", h, w2) + b2

    x = A_u
    xn = _layernorm(x, axis=-1)
    return x + _A_ref(xn, A_A_re, A_A_im, A_B_re, A_B_im, A_C_re, A_C_im, A_log_dt, A_Dskip) + _B_ref(xn, B_w1, B_b1, B_w2, B_b2)
```

```asm
; @launch kernel=prep_kernel grid=(1216,1,1) block=(256,1,1) lds=8704
; @launch kernel=mid_kernel grid=(480,1,1) block=(256,1,1) lds=73728
; @launch kernel=fin_kernel grid=(256,1,1) block=(256,1,1) lds=131072
.amdgcn_target "amdgcn-amd-amdhsa--gfx950"
.text
.globl prep_kernel
.type prep_kernel,@function
.globl mid_kernel
.type mid_kernel,@function
.globl fin_kernel
.type fin_kernel,@function
.p2align 8
prep_kernel:
s_cmp_ge_u32 s2, 1216
s_cbranch_scc1 prep_end
s_load_dwordx2 s[4:5], s[0:1], 128
s_waitcnt lgkmcnt(0)
s_mov_b32 s8, s4
s_and_b32 s9, s5, 0xffff
s_mov_b32 s10, 33554432
s_mov_b32 s11, 0x00020000
s_cmp_ge_u32 s2, 256
s_cbranch_scc1 prep_not_ln
s_load_dwordx2 s[6:7], s[0:1], 0
s_waitcnt lgkmcnt(0)
s_mov_b32 s12, s6
s_and_b32 s13, s7, 0xffff
s_mov_b32 s14, 2097152
s_mov_b32 s15, 0x00020000
v_lshrrev_b32 v1, 5, v0
v_and_b32 v2, 31, v0
v_lshlrev_b32 v3, 10, v1
v_lshl_add_u32 v3, v2, 5, v3
s_lshl_b32 s3, s2, 13
v_add_u32 v4, s3, v3
buffer_load_dwordx4 v[8:11], v4, s[12:15], 0 offen
buffer_load_dwordx4 v[12:15], v4, s[12:15], 0 offen offset:16
s_waitcnt vmcnt(0)
v_lshlrev_b32 v16, 16, v8
v_and_b32 v17, 0xffff0000, v8
v_lshlrev_b32 v18, 16, v9
v_and_b32 v19, 0xffff0000, v9
v_lshlrev_b32 v20, 16, v10
v_and_b32 v21, 0xffff0000, v10
v_lshlrev_b32 v22, 16, v11
v_and_b32 v23, 0xffff0000, v11
v_lshlrev_b32 v24, 16, v12
v_and_b32 v25, 0xffff0000, v12
v_lshlrev_b32 v26, 16, v13
v_and_b32 v27, 0xffff0000, v13
v_lshlrev_b32 v28, 16, v14
v_and_b32 v29, 0xffff0000, v14
v_lshlrev_b32 v30, 16, v15
v_and_b32 v31, 0xffff0000, v15
v_add_f32 v40, v16, v17
v_add_f32 v40, v40, v18
v_add_f32 v40, v40, v19
v_add_f32 v40, v40, v20
v_add_f32 v40, v40, v21
v_add_f32 v40, v40, v22
v_add_f32 v40, v40, v23
v_add_f32 v40, v40, v24
v_add_f32 v40, v40, v25
v_add_f32 v40, v40, v26
v_add_f32 v40, v40, v27
v_add_f32 v40, v40, v28
v_add_f32 v40, v40, v29
v_add_f32 v40, v40, v30
v_add_f32 v40, v40, v31
s_nop 1
v_add_f32_dpp v41, v40, v40 row_ror:8 row_mask:0xf bank_mask:0xf
s_nop 1
v_add_f32_dpp v40, v41, v41 row_ror:4 row_mask:0xf bank_mask:0xf
s_nop 1
v_add_f32_dpp v41, v40, v40 row_ror:2 row_mask:0xf bank_mask:0xf
s_nop 1
v_add_f32_dpp v40, v41, v41 row_ror:1 row_mask:0xf bank_mask:0xf
s_nop 1
ds_swizzle_b32 v42, v40 offset:0x401F
s_waitcnt lgkmcnt(0)
v_add_f32 v40, v40, v42
v_mul_f32 v40, 0x3b000000, v40
v_sub_f32 v41, v16, v40
v_mul_f32 v41, v41, v41
v_sub_f32 v42, v17, v40
v_fmac_f32 v41, v42, v42
v_sub_f32 v42, v18, v40
v_fmac_f32 v41, v42, v42
v_sub_f32 v42, v19, v40
v_fmac_f32 v41, v42, v42
v_sub_f32 v42, v20, v40
v_fmac_f32 v41, v42, v42
v_sub_f32 v42, v21, v40
v_fmac_f32 v41, v42, v42
v_sub_f32 v42, v22, v40
v_fmac_f32 v41, v42, v42
v_sub_f32 v42, v23, v40
v_fmac_f32 v41, v42, v42
v_sub_f32 v42, v24, v40
v_fmac_f32 v41, v42, v42
v_sub_f32 v42, v25, v40
v_fmac_f32 v41, v42, v42
v_sub_f32 v42, v26, v40
v_fmac_f32 v41, v42, v42
v_sub_f32 v42, v27, v40
v_fmac_f32 v41, v42, v42
v_sub_f32 v42, v28, v40
v_fmac_f32 v41, v42, v42
v_sub_f32 v42, v29, v40
v_fmac_f32 v41, v42, v42
v_sub_f32 v42, v30, v40
v_fmac_f32 v41, v42, v42
v_sub_f32 v42, v31, v40
v_fmac_f32 v41, v42, v42
s_nop 1
v_add_f32_dpp v62, v41, v41 row_ror:8 row_mask:0xf bank_mask:0xf
s_nop 1
v_add_f32_dpp v41, v62, v62 row_ror:4 row_mask:0xf bank_mask:0xf
s_nop 1
v_add_f32_dpp v62, v41, v41 row_ror:2 row_mask:0xf bank_mask:0xf
s_nop 1
v_add_f32_dpp v41, v62, v62 row_ror:1 row_mask:0xf bank_mask:0xf
s_nop 1
ds_swizzle_b32 v63, v41 offset:0x401F
s_waitcnt lgkmcnt(0)
v_add_f32 v41, v41, v63
v_mul_f32 v41, 0x3b000000, v41
v_cvt_pk_bf16_f32 v63, v40, v41
v_lshlrev_b32 v40, 16, v63
v_and_b32 v41, 0xffff0000, v63
v_add_f32 v41, 0x3727c5ac, v41
v_cvt_pk_bf16_f32 v63, v41, v41
v_lshlrev_b32 v41, 16, v63
v_sqrt_f32 v41, v41
s_nop 0
v_cvt_pk_bf16_f32 v63, v41, v41
v_lshlrev_b32 v41, 16, v63
v_rcp_f32 v41, v41
s_nop 0
v_sub_f32 v16, v16, v40
v_sub_f32 v17, v17, v40
v_cvt_pk_bf16_f32 v63, v16, v17
v_lshlrev_b32 v16, 16, v63
v_and_b32 v17, 0xffff0000, v63
v_mul_f32 v16, v16, v41
v_mul_f32 v17, v17, v41
v_cvt_pk_bf16_f32 v63, v16, v17
v_lshlrev_b32 v16, 16, v63
v_and_b32 v17, 0xffff0000, v63
v_sub_f32 v18, v18, v40
v_sub_f32 v19, v19, v40
v_cvt_pk_bf16_f32 v63, v18, v19
v_lshlrev_b32 v18, 16, v63
v_and_b32 v19, 0xffff0000, v63
v_mul_f32 v18, v18, v41
v_mul_f32 v19, v19, v41
v_cvt_pk_bf16_f32 v63, v18, v19
v_lshlrev_b32 v18, 16, v63
v_and_b32 v19, 0xffff0000, v63
v_sub_f32 v20, v20, v40
v_sub_f32 v21, v21, v40
v_cvt_pk_bf16_f32 v63, v20, v21
v_lshlrev_b32 v20, 16, v63
v_and_b32 v21, 0xffff0000, v63
v_mul_f32 v20, v20, v41
v_mul_f32 v21, v21, v41
v_cvt_pk_bf16_f32 v63, v20, v21
v_lshlrev_b32 v20, 16, v63
v_and_b32 v21, 0xffff0000, v63
v_sub_f32 v22, v22, v40
v_sub_f32 v23, v23, v40
v_cvt_pk_bf16_f32 v63, v22, v23
v_lshlrev_b32 v22, 16, v63
v_and_b32 v23, 0xffff0000, v63
v_mul_f32 v22, v22, v41
v_mul_f32 v23, v23, v41
v_cvt_pk_bf16_f32 v63, v22, v23
v_lshlrev_b32 v22, 16, v63
v_and_b32 v23, 0xffff0000, v63
v_sub_f32 v24, v24, v40
v_sub_f32 v25, v25, v40
v_cvt_pk_bf16_f32 v63, v24, v25
v_lshlrev_b32 v24, 16, v63
v_and_b32 v25, 0xffff0000, v63
v_mul_f32 v24, v24, v41
v_mul_f32 v25, v25, v41
v_cvt_pk_bf16_f32 v63, v24, v25
v_lshlrev_b32 v24, 16, v63
v_and_b32 v25, 0xffff0000, v63
v_sub_f32 v26, v26, v40
v_sub_f32 v27, v27, v40
v_cvt_pk_bf16_f32 v63, v26, v27
v_lshlrev_b32 v26, 16, v63
v_and_b32 v27, 0xffff0000, v63
v_mul_f32 v26, v26, v41
v_mul_f32 v27, v27, v41
v_cvt_pk_bf16_f32 v63, v26, v27
v_lshlrev_b32 v26, 16, v63
v_and_b32 v27, 0xffff0000, v63
v_sub_f32 v28, v28, v40
v_sub_f32 v29, v29, v40
v_cvt_pk_bf16_f32 v63, v28, v29
v_lshlrev_b32 v28, 16, v63
v_and_b32 v29, 0xffff0000, v63
v_mul_f32 v28, v28, v41
v_mul_f32 v29, v29, v41
v_cvt_pk_bf16_f32 v63, v28, v29
v_lshlrev_b32 v28, 16, v63
v_and_b32 v29, 0xffff0000, v63
v_sub_f32 v30, v30, v40
v_sub_f32 v31, v31, v40
v_cvt_pk_bf16_f32 v63, v30, v31
v_lshlrev_b32 v30, 16, v63
v_and_b32 v31, 0xffff0000, v63
v_mul_f32 v30, v30, v41
v_mul_f32 v31, v31, v41
v_cvt_pk_bf16_f32 v63, v30, v31
v_lshlrev_b32 v30, 16, v63
v_and_b32 v31, 0xffff0000, v63
v_cvt_pk_bf16_f32 v8, v16, v17
v_cvt_pk_bf16_f32 v9, v18, v19
v_cvt_pk_bf16_f32 v10, v20, v21
v_cvt_pk_bf16_f32 v11, v22, v23
v_cvt_pk_bf16_f32 v12, v24, v25
v_cvt_pk_bf16_f32 v13, v26, v27
v_cvt_pk_bf16_f32 v14, v28, v29
v_cvt_pk_bf16_f32 v15, v30, v31
ds_write_b128 v3, v[8:11]
ds_write_b128 v3, v[12:15] offset:16
v_add_f32 v40, v16, v17
v_add_f32 v40, v40, v18
v_add_f32 v40, v40, v19
v_add_f32 v40, v40, v20
v_add_f32 v40, v40, v21
v_add_f32 v40, v40, v22
v_add_f32 v40, v40, v23
v_add_f32 v40, v40, v24
v_add_f32 v40, v40, v25
v_add_f32 v40, v40, v26
v_add_f32 v40, v40, v27
v_add_f32 v40, v40, v28
v_add_f32 v40, v40, v29
v_add_f32 v40, v40, v30
v_add_f32 v40, v40, v31
s_nop 1
v_add_f32_dpp v41, v40, v40 row_ror:8 row_mask:0xf bank_mask:0xf
s_nop 1
v_add_f32_dpp v40, v41, v41 row_ror:4 row_mask:0xf bank_mask:0xf
s_nop 1
v_add_f32_dpp v41, v40, v40 row_ror:2 row_mask:0xf bank_mask:0xf
s_nop 1
v_add_f32_dpp v40, v41, v41 row_ror:1 row_mask:0xf bank_mask:0xf
s_nop 1
ds_swizzle_b32 v42, v40 offset:0x401F
s_waitcnt lgkmcnt(0)
v_add_f32 v40, v40, v42
v_mul_f32 v40, 0x3b000000, v40
v_sub_f32 v41, v16, v40
v_mul_f32 v41, v41, v41
v_sub_f32 v42, v17, v40
v_fmac_f32 v41, v42, v42
v_sub_f32 v42, v18, v40
v_fmac_f32 v41, v42, v42
v_sub_f32 v42, v19, v40
v_fmac_f32 v41, v42, v42
v_sub_f32 v42, v20, v40
v_fmac_f32 v41, v42, v42
v_sub_f32 v42, v21, v40
v_fmac_f32 v41, v42, v42
v_sub_f32 v42, v22, v40
v_fmac_f32 v41, v42, v42
v_sub_f32 v42, v23, v40
v_fmac_f32 v41, v42, v42
v_sub_f32 v42, v24, v40
v_fmac_f32 v41, v42, v42
v_sub_f32 v42, v25, v40
v_fmac_f32 v41, v42, v42
v_sub_f32 v42, v26, v40
v_fmac_f32 v41, v42, v42
v_sub_f32 v42, v27, v40
v_fmac_f32 v41, v42, v42
v_sub_f32 v42, v28, v40
v_fmac_f32 v41, v42, v42
v_sub_f32 v42, v29, v40
v_fmac_f32 v41, v42, v42
v_sub_f32 v42, v30, v40
v_fmac_f32 v41, v42, v42
v_sub_f32 v42, v31, v40
v_fmac_f32 v41, v42, v42
s_nop 1
v_add_f32_dpp v62, v41, v41 row_ror:8 row_mask:0xf bank_mask:0xf
s_nop 1
v_add_f32_dpp v41, v62, v62 row_ror:4 row_mask:0xf bank_mask:0xf
s_nop 1
v_add_f32_dpp v62, v41, v41 row_ror:2 row_mask:0xf bank_mask:0xf
s_nop 1
v_add_f32_dpp v41, v62, v62 row_ror:1 row_mask:0xf bank_mask:0xf
s_nop 1
ds_swizzle_b32 v63, v41 offset:0x401F
s_waitcnt lgkmcnt(0)
v_add_f32 v41, v41, v63
v_mul_f32 v41, 0x3b000000, v41
v_cvt_pk_bf16_f32 v63, v40, v41
v_lshlrev_b32 v40, 16, v63
v_and_b32 v41, 0xffff0000, v63
v_add_f32 v41, 0x3727c5ac, v41
v_cvt_pk_bf16_f32 v63, v41, v41
v_lshlrev_b32 v41, 16, v63
v_sqrt_f32 v41, v41
s_nop 0
v_cvt_pk_bf16_f32 v63, v41, v41
v_lshlrev_b32 v41, 16, v63
v_rcp_f32 v41, v41
s_nop 0
v_sub_f32 v16, v16, v40
v_sub_f32 v17, v17, v40
v_cvt_pk_bf16_f32 v63, v16, v17
v_lshlrev_b32 v16, 16, v63
v_and_b32 v17, 0xffff0000, v63
v_mul_f32 v16, v16, v41
v_mul_f32 v17, v17, v41
v_cvt_pk_bf16_f32 v63, v16, v17
v_lshlrev_b32 v16, 16, v63
v_and_b32 v17, 0xffff0000, v63
v_sub_f32 v18, v18, v40
v_sub_f32 v19, v19, v40
v_cvt_pk_bf16_f32 v63, v18, v19
v_lshlrev_b32 v18, 16, v63
v_and_b32 v19, 0xffff0000, v63
v_mul_f32 v18, v18, v41
v_mul_f32 v19, v19, v41
v_cvt_pk_bf16_f32 v63, v18, v19
v_lshlrev_b32 v18, 16, v63
v_and_b32 v19, 0xffff0000, v63
v_sub_f32 v20, v20, v40
v_sub_f32 v21, v21, v40
v_cvt_pk_bf16_f32 v63, v20, v21
v_lshlrev_b32 v20, 16, v63
v_and_b32 v21, 0xffff0000, v63
v_mul_f32 v20, v20, v41
v_mul_f32 v21, v21, v41
v_cvt_pk_bf16_f32 v63, v20, v21
v_lshlrev_b32 v20, 16, v63
v_and_b32 v21, 0xffff0000, v63
v_sub_f32 v22, v22, v40
v_sub_f32 v23, v23, v40
v_cvt_pk_bf16_f32 v63, v22, v23
v_lshlrev_b32 v22, 16, v63
v_and_b32 v23, 0xffff0000, v63
v_mul_f32 v22, v22, v41
v_mul_f32 v23, v23, v41
v_cvt_pk_bf16_f32 v63, v22, v23
v_lshlrev_b32 v22, 16, v63
v_and_b32 v23, 0xffff0000, v63
v_sub_f32 v24, v24, v40
v_sub_f32 v25, v25, v40
v_cvt_pk_bf16_f32 v63, v24, v25
v_lshlrev_b32 v24, 16, v63
v_and_b32 v25, 0xffff0000, v63
v_mul_f32 v24, v24, v41
v_mul_f32 v25, v25, v41
v_cvt_pk_bf16_f32 v63, v24, v25
v_lshlrev_b32 v24, 16, v63
v_and_b32 v25, 0xffff0000, v63
v_sub_f32 v26, v26, v40
v_sub_f32 v27, v27, v40
v_cvt_pk_bf16_f32 v63, v26, v27
v_lshlrev_b32 v26, 16, v63
v_and_b32 v27, 0xffff0000, v63
v_mul_f32 v26, v26, v41
v_mul_f32 v27, v27, v41
v_cvt_pk_bf16_f32 v63, v26, v27
v_lshlrev_b32 v26, 16, v63
v_and_b32 v27, 0xffff0000, v63
v_sub_f32 v28, v28, v40
v_sub_f32 v29, v29, v40
v_cvt_pk_bf16_f32 v63, v28, v29
v_lshlrev_b32 v28, 16, v63
v_and_b32 v29, 0xffff0000, v63
v_mul_f32 v28, v28, v41
v_mul_f32 v29, v29, v41
v_cvt_pk_bf16_f32 v63, v28, v29
v_lshlrev_b32 v28, 16, v63
v_and_b32 v29, 0xffff0000, v63
v_sub_f32 v30, v30, v40
v_sub_f32 v31, v31, v40
v_cvt_pk_bf16_f32 v63, v30, v31
v_lshlrev_b32 v30, 16, v63
v_and_b32 v31, 0xffff0000, v63
v_mul_f32 v30, v30, v41
v_mul_f32 v31, v31, v41
v_cvt_pk_bf16_f32 v63, v30, v31
v_lshlrev_b32 v30, 16, v63
v_and_b32 v31, 0xffff0000, v63
v_cvt_pk_bf16_f32 v8, v16, v17
v_cvt_pk_bf16_f32 v9, v18, v19
v_cvt_pk_bf16_f32 v10, v20, v21
v_cvt_pk_bf16_f32 v11, v22, v23
v_cvt_pk_bf16_f32 v12, v24, v25
v_cvt_pk_bf16_f32 v13, v26, v27
v_cvt_pk_bf16_f32 v14, v28, v29
v_cvt_pk_bf16_f32 v15, v30, v31
buffer_store_dwordx4 v[8:11], v4, s[8:11], 0 offen
buffer_store_dwordx4 v[12:15], v4, s[8:11], 0 offen offset:16
s_waitcnt lgkmcnt(0)
s_barrier
v_lshlrev_b32 v5, 1, v0
ds_read_u16 v16, v5 offset:0
ds_read_u16 v17, v5 offset:1024
ds_read_u16 v18, v5 offset:2048
ds_read_u16 v19, v5 offset:3072
ds_read_u16 v20, v5 offset:4096
ds_read_u16 v21, v5 offset:5120
ds_read_u16 v22, v5 offset:6144
ds_read_u16 v23, v5 offset:7168
s_waitcnt lgkmcnt(0)
v_lshl_or_b32 v24, v17, 16, v16
v_lshl_or_b32 v25, v19, 16, v18
v_lshl_or_b32 v26, v21, 16, v20
v_lshl_or_b32 v27, v23, 16, v22
v_lshlrev_b32 v6, 4, v0
s_add_u32 s16, s3, 2097152
buffer_store_dwordx4 v[24:27], v6, s[8:11], s16 offen
s_nop 1
v_lshlrev_b32 v5, 1, v0
ds_read_u16 v16, v5 offset:512
ds_read_u16 v17, v5 offset:1536
ds_read_u16 v18, v5 offset:2560
ds_read_u16 v19, v5 offset:3584
ds_read_u16 v20, v5 offset:4608
ds_read_u16 v21, v5 offset:5632
ds_read_u16 v22, v5 offset:6656
ds_read_u16 v23, v5 offset:7680
s_waitcnt lgkmcnt(0)
v_lshl_or_b32 v24, v17, 16, v16
v_lshl_or_b32 v25, v19, 16, v18
v_lshl_or_b32 v26, v21, 16, v20
v_lshl_or_b32 v27, v23, 16, v22
v_lshlrev_b32 v6, 4, v0
s_add_u32 s16, s3, 2101248
buffer_store_dwordx4 v[24:27], v6, s[8:11], s16 offen
s_nop 1
s_branch prep_end
prep_not_ln:
s_cmp_ge_u32 s2, 768
s_cbranch_scc1 prep_trans
s_sub_u32 s3, s2, 256
s_load_dwordx8 s[16:23], s[0:1], 8
s_load_dwordx4 s[24:27], s[0:1], 40
s_load_dwordx2 s[28:29], s[0:1], 56
v_lshrrev_b32 v1, 6, v0
v_and_b32 v2, 15, v0
v_bfe_u32 v3, v0, 4, 2
s_lshl_b32 s30, s3, 8
v_and_b32 v4, 127, v0
v_lshlrev_b32 v4, 1, v4
v_add_u32 v4, s30, v4
s_waitcnt lgkmcnt(0)
s_mov_b32 s32, s28
s_and_b32 s33, s29, 0xffff
s_mov_b32 s34, 1024
s_mov_b32 s35, 0x00020000
s_lshl_b32 s31, s3, 1
v_mov_b32 v5, s31
buffer_load_ushort v5, v5, s[32:35], 0 offen
s_mov_b32 s40, s16
s_and_b32 s41, s17, 0xffff
s_mov_b32 s42, 131072
s_mov_b32 s43, 0x00020000
s_mov_b32 s44, s18
s_and_b32 s45, s19, 0xffff
s_mov_b32 s46, 131072
s_mov_b32 s47, 0x00020000
s_mov_b32 s48, s20
s_and_b32 s49, s21, 0xffff
s_mov_b32 s50, 131072
s_mov_b32 s51, 0x00020000
s_mov_b32 s52, s22
s_and_b32 s53, s23, 0xffff
s_mov_b32 s54, 131072
s_mov_b32 s55, 0x00020000
s_mov_b32 s56, s24
s_and_b32 s57, s25, 0xffff
s_mov_b32 s58, 131072
s_mov_b32 s59, 0x00020000
s_mov_b32 s60, s26
s_and_b32 s61, s27, 0xffff
s_mov_b32 s62, 131072
s_mov_b32 s63, 0x00020000
buffer_load_ushort v24, v4, s[40:43], 0 offen
buffer_load_ushort v25, v4, s[44:47], 0 offen
buffer_load_ushort v26, v4, s[48:51], 0 offen
buffer_load_ushort v27, v4, s[52:55], 0 offen
buffer_load_ushort v28, v4, s[56:59], 0 offen
buffer_load_ushort v29, v4, s[60:63], 0 offen
s_waitcnt vmcnt(0)
v_lshlrev_b32 v5, 16, v5
v_mul_f32 v5, 1069066811, v5
v_exp_f32 v5, v5
s_nop 0
v_cvt_pk_bf16_f32 v5, v5, v5
v_lshlrev_b32 v5, 16, v5
v_lshlrev_b32 v24, 16, v24
v_lshlrev_b32 v25, 16, v25
v_lshlrev_b32 v26, 16, v26
v_lshlrev_b32 v27, 16, v27
v_lshlrev_b32 v28, 16, v28
v_lshlrev_b32 v29, 16, v29
v_mul_f32 v24, v24, v5
v_mul_f32 v25, v25, v5
v_mul_f32 v26, v26, v5
v_mul_f32 v27, v27, v5
v_mul_f32 v32, 1069066811, v24
v_mul_f32 v33, 1042479491, v25
v_mul_f32 v34, v28, v26
v_fma_f32 v34, -v29, v27, v34
v_mul_f32 v35, v28, v27
v_fma_f32 v35, v29, v26, v35
v_and_b32 v6, 127, v0
v_lshlrev_b32 v6, 4, v6
ds_write_b128 v6, v[32:35]
s_waitcnt lgkmcnt(0)
s_barrier
v_cvt_f32_u32 v6, v2
v_lshlrev_b32 v7, v1, 1
v_cvt_f32_u32 v7, v7
v_mul_f32 v8, v6, v7
v_mul_f32 v9, 16.0, v8
v_mul_f32 v10, 0x43000000, v7
v_cmp_eq_u32 vcc, 0, v1
s_nop 1
v_cndmask_b32 v10, v10, 0, vcc
v_add_f32 v9, v9, v10
v_lshlrev_b32 v11, 9, v3
v_mov_b32 v12, 0
v_mov_b32 v13, 0
v_mov_b32 v14, 0
v_mov_b32 v15, 0
ds_read_b128 v[64:67], v11 offset:0
ds_read_b128 v[68:71], v11 offset:16
ds_read_b128 v[72:75], v11 offset:32
ds_read_b128 v[76:79], v11 offset:48
ds_read_b128 v[80:83], v11 offset:64
ds_read_b128 v[84:87], v11 offset:80
ds_read_b128 v[88:91], v11 offset:96
ds_read_b128 v[92:95], v11 offset:112
ds_read_b128 v[96:99], v11 offset:128
ds_read_b128 v[100:103], v11 offset:144
ds_read_b128 v[104:107], v11 offset:160
ds_read_b128 v[108:111], v11 offset:176
ds_read_b128 v[112:115], v11 offset:192
ds_read_b128 v[116:119], v11 offset:208
ds_read_b128 v[120:123], v11 offset:224
ds_read_b128 v[124:127], v11 offset:240
s_waitcnt lgkmcnt(0)
v_mul_f32 v26, v64, v8
v_mul_f32 v34, v68, v8
v_mul_f32 v42, v72, v8
v_mul_f32 v50, v76, v8
v_exp_f32 v26, v26
v_exp_f32 v34, v34
v_exp_f32 v42, v42
v_exp_f32 v50, v50
v_mul_f32 v27, v65, v8
v_mul_f32 v35, v69, v8
v_mul_f32 v43, v73, v8
v_mul_f32 v51, v77, v8
v_fract_f32 v27, v27
v_fract_f32 v35, v35
v_fract_f32 v43, v43
v_fract_f32 v51, v51
v_cos_f32 v24, v27
v_cos_f32 v32, v35
v_cos_f32 v40, v43
v_cos_f32 v48, v51
v_sin_f32 v25, v27
v_sin_f32 v33, v35
v_sin_f32 v41, v43
v_sin_f32 v49, v51
v_mul_f32 v24, v24, v26
v_mul_f32 v32, v32, v34
v_mul_f32 v40, v40, v42
v_mul_f32 v48, v48, v50
v_mul_f32 v25, v25, v26
v_mul_f32 v33, v33, v34
v_mul_f32 v41, v41, v42
v_mul_f32 v49, v49, v50
v_cvt_pk_bf16_f32 v20, v24, v25
v_cvt_pk_bf16_f32 v21, v32, v33
v_cvt_pk_bf16_f32 v22, v40, v41
v_cvt_pk_bf16_f32 v23, v48, v49
v_mul_f32 v26, v64, v9
v_mul_f32 v34, v68, v9
v_mul_f32 v42, v72, v9
v_mul_f32 v50, v76, v9
v_exp_f32 v26, v26
v_exp_f32 v34, v34
v_exp_f32 v42, v42
v_exp_f32 v50, v50
v_mul_f32 v27, v65, v9
v_mul_f32 v35, v69, v9
v_mul_f32 v43, v73, v9
v_mul_f32 v51, v77, v9
v_fract_f32 v27, v27
v_fract_f32 v35, v35
v_fract_f32 v43, v43
v_fract_f32 v51, v51
v_cos_f32 v24, v27
v_cos_f32 v32, v35
v_cos_f32 v40, v43
v_cos_f32 v48, v51
v_sin_f32 v25, v27
v_sin_f32 v33, v35
v_sin_f32 v41, v43
v_sin_f32 v49, v51
v_mul_f32 v24, v24, v26
v_mul_f32 v32, v32, v34
v_mul_f32 v40, v40, v42
v_mul_f32 v48, v48, v50
v_mul_f32 v25, v25, v26
v_mul_f32 v33, v33, v34
v_mul_f32 v41, v41, v42
v_mul_f32 v49, v49, v50
v_mul_f32 v28, v66, v24
v_mul_f32 v36, v70, v32
v_mul_f32 v44, v74, v40
v_mul_f32 v52, v78, v48
v_fma_f32 v28, -v67, v25, v28
v_fma_f32 v36, -v71, v33, v36
v_fma_f32 v44, -v75, v41, v44
v_fma_f32 v52, -v79, v49, v52
v_mul_f32 v29, v66, v25
v_mul_f32 v37, v70, v33
v_mul_f32 v45, v74, v41
v_mul_f32 v53, v78, v49
v_fma_f32 v29, v67, v24, v29
v_fma_f32 v37, v71, v32, v37
v_fma_f32 v45, v75, v40, v45
v_fma_f32 v53, v79, v48, v53
v_cvt_pk_bf16_f32 v16, v28, -v29
v_cvt_pk_bf16_f32 v17, v36, -v37
v_cvt_pk_bf16_f32 v18, v44, -v45
v_cvt_pk_bf16_f32 v19, v52, -v53
s_nop 1
v_mfma_f32_16x16x32_bf16 v[12:15], v[16:19], v[20:23], v[12:15]
s_nop 3
v_mul_f32 v26, v80, v8
v_mul_f32 v34, v84, v8
v_mul_f32 v42, v88, v8
v_mul_f32 v50, v92, v8
v_exp_f32 v26, v26
v_exp_f32 v34, v34
v_exp_f32 v42, v42
v_exp_f32 v50, v50
v_mul_f32 v27, v81, v8
v_mul_f32 v35, v85, v8
v_mul_f32 v43, v89, v8
v_mul_f32 v51, v93, v8
v_fract_f32 v27, v27
v_fract_f32 v35, v35
v_fract_f32 v43, v43
v_fract_f32 v51, v51
v_cos_f32 v24, v27
v_cos_f32 v32, v35
v_cos_f32 v40, v43
v_cos_f32 v48, v51
v_sin_f32 v25, v27
v_sin_f32 v33, v35
v_sin_f32 v41, v43
v_sin_f32 v49, v51
v_mul_f32 v24, v24, v26
v_mul_f32 v32, v32, v34
v_mul_f32 v40, v40, v42
v_mul_f32 v48, v48, v50
v_mul_f32 v25, v25, v26
v_mul_f32 v33, v33, v34
v_mul_f32 v41, v41, v42
v_mul_f32 v49, v49, v50
v_cvt_pk_bf16_f32 v20, v24, v25
v_cvt_pk_bf16_f32 v21, v32, v33
v_cvt_pk_bf16_f32 v22, v40, v41
v_cvt_pk_bf16_f32 v23, v48, v49
v_mul_f32 v26, v80, v9
v_mul_f32 v34, v84, v9
v_mul_f32 v42, v88, v9
v_mul_f32 v50, v92, v9
v_exp_f32 v26, v26
v_exp_f32 v34, v34
v_exp_f32 v42, v42
v_exp_f32 v50, v50
v_mul_f32 v27, v81, v9
v_mul_f32 v35, v85, v9
v_mul_f32 v43, v89, v9
v_mul_f32 v51, v93, v9
v_fract_f32 v27, v27
v_fract_f32 v35, v35
v_fract_f32 v43, v43
v_fract_f32 v51, v51
v_cos_f32 v24, v27
v_cos_f32 v32, v35
v_cos_f32 v40, v43
v_cos_f32 v48, v51
v_sin_f32 v25, v27
v_sin_f32 v33, v35
v_sin_f32 v41, v43
v_sin_f32 v49, v51
v_mul_f32 v24, v24, v26
v_mul_f32 v32, v32, v34
v_mul_f32 v40, v40, v42
v_mul_f32 v48, v48, v50
v_mul_f32 v25, v25, v26
v_mul_f32 v33, v33, v34
v_mul_f32 v41, v41, v42
v_mul_f32 v49, v49, v50
v_mul_f32 v28, v82, v24
v_mul_f32 v36, v86, v32
v_mul_f32 v44, v90, v40
v_mul_f32 v52, v94, v48
v_fma_f32 v28, -v83, v25, v28
v_fma_f32 v36, -v87, v33, v36
v_fma_f32 v44, -v91, v41, v44
v_fma_f32 v52, -v95, v49, v52
v_mul_f32 v29, v82, v25
v_mul_f32 v37, v86, v33
v_mul_f32 v45, v90, v41
v_mul_f32 v53, v94, v49
v_fma_f32 v29, v83, v24, v29
v_fma_f32 v37, v87, v32, v37
v_fma_f32 v45, v91, v40, v45
v_fma_f32 v53, v95, v48, v53
v_cvt_pk_bf16_f32 v16, v28, -v29
v_cvt_pk_bf16_f32 v17, v36, -v37
v_cvt_pk_bf16_f32 v18, v44, -v45
v_cvt_pk_bf16_f32 v19, v52, -v53
s_nop 1
v_mfma_f32_16x16x32_bf16 v[12:15], v[16:19], v[20:23], v[12:15]
s_nop 3
v_mul_f32 v26, v96, v8
v_mul_f32 v34, v100, v8
v_mul_f32 v42, v104, v8
v_mul_f32 v50, v108, v8
v_exp_f32 v26, v26
v_exp_f32 v34, v34
v_exp_f32 v42, v42
v_exp_f32 v50, v50
v_mul_f32 v27, v97, v8
v_mul_f32 v35, v101, v8
v_mul_f32 v43, v105, v8
v_mul_f32 v51, v109, v8
v_fract_f32 v27, v27
v_fract_f32 v35, v35
v_fract_f32 v43, v43
v_fract_f32 v51, v51
v_cos_f32 v24, v27
v_cos_f32 v32, v35
v_cos_f32 v40, v43
v_cos_f32 v48, v51
v_sin_f32 v25, v27
v_sin_f32 v33, v35
v_sin_f32 v41, v43
v_sin_f32 v49, v51
v_mul_f32 v24, v24, v26
v_mul_f32 v32, v32, v34
v_mul_f32 v40, v40, v42
v_mul_f32 v48, v48, v50
v_mul_f32 v25, v25, v26
v_mul_f32 v33, v33, v34
v_mul_f32 v41, v41, v42
v_mul_f32 v49, v49, v50
v_cvt_pk_bf16_f32 v20, v24, v25
v_cvt_pk_bf16_f32 v21, v32, v33
v_cvt_pk_bf16_f32 v22, v40, v41
v_cvt_pk_bf16_f32 v23, v48, v49
v_mul_f32 v26, v96, v9
v_mul_f32 v34, v100, v9
v_mul_f32 v42, v104, v9
v_mul_f32 v50, v108, v9
v_exp_f32 v26, v26
v_exp_f32 v34, v34
v_exp_f32 v42, v42
v_exp_f32 v50, v50
v_mul_f32 v27, v97, v9
v_mul_f32 v35, v101, v9
v_mul_f32 v43, v105, v9
v_mul_f32 v51, v109, v9
v_fract_f32 v27, v27
v_fract_f32 v35, v35
v_fract_f32 v43, v43
v_fract_f32 v51, v51
v_cos_f32 v24, v27
v_cos_f32 v32, v35
v_cos_f32 v40, v43
v_cos_f32 v48, v51
v_sin_f32 v25, v27
v_sin_f32 v33, v35
v_sin_f32 v41, v43
v_sin_f32 v49, v51
v_mul_f32 v24, v24, v26
v_mul_f32 v32, v32, v34
v_mul_f32 v40, v40, v42
v_mul_f32 v48, v48, v50
v_mul_f32 v25, v25, v26
v_mul_f32 v33, v33, v34
v_mul_f32 v41, v41, v42
v_mul_f32 v49, v49, v50
v_mul_f32 v28, v98, v24
v_mul_f32 v36, v102, v32
v_mul_f32 v44, v106, v40
v_mul_f32 v52, v110, v48
v_fma_f32 v28, -v99, v25, v28
v_fma_f32 v36, -v103, v33, v36
v_fma_f32 v44, -v107, v41, v44
v_fma_f32 v52, -v111, v49, v52
v_mul_f32 v29, v98, v25
v_mul_f32 v37, v102, v33
v_mul_f32 v45, v106, v41
v_mul_f32 v53, v110, v49
v_fma_f32 v29, v99, v24, v29
v_fma_f32 v37, v103, v32, v37
v_fma_f32 v45, v107, v40, v45
v_fma_f32 v53, v111, v48, v53
v_cvt_pk_bf16_f32 v16, v28, -v29
v_cvt_pk_bf16_f32 v17, v36, -v37
v_cvt_pk_bf16_f32 v18, v44, -v45
v_cvt_pk_bf16_f32 v19, v52, -v53
s_nop 1
v_mfma_f32_16x16x32_bf16 v[12:15], v[16:19], v[20:23], v[12:15]
s_nop 3
v_mul_f32 v26, v112, v8
v_mul_f32 v34, v116, v8
v_mul_f32 v42, v120, v8
v_mul_f32 v50, v124, v8
v_exp_f32 v26, v26
v_exp_f32 v34, v34
v_exp_f32 v42, v42
v_exp_f32 v50, v50
v_mul_f32 v27, v113, v8
v_mul_f32 v35, v117, v8
v_mul_f32 v43, v121, v8
v_mul_f32 v51, v125, v8
v_fract_f32 v27, v27
v_fract_f32 v35, v35
v_fract_f32 v43, v43
v_fract_f32 v51, v51
v_cos_f32 v24, v27
v_cos_f32 v32, v35
v_cos_f32 v40, v43
v_cos_f32 v48, v51
v_sin_f32 v25, v27
v_sin_f32 v33, v35
v_sin_f32 v41, v43
v_sin_f32 v49, v51
v_mul_f32 v24, v24, v26
v_mul_f32 v32, v32, v34
v_mul_f32 v40, v40, v42
v_mul_f32 v48, v48, v50
v_mul_f32 v25, v25, v26
v_mul_f32 v33, v33, v34
v_mul_f32 v41, v41, v42
v_mul_f32 v49, v49, v50
v_cvt_pk_bf16_f32 v20, v24, v25
v_cvt_pk_bf16_f32 v21, v32, v33
v_cvt_pk_bf16_f32 v22, v40, v41
v_cvt_pk_bf16_f32 v23, v48, v49
v_mul_f32 v26, v112, v9
v_mul_f32 v34, v116, v9
v_mul_f32 v42, v120, v9
v_mul_f32 v50, v124, v9
v_exp_f32 v26, v26
v_exp_f32 v34, v34
v_exp_f32 v42, v42
v_exp_f32 v50, v50
v_mul_f32 v27, v113, v9
v_mul_f32 v35, v117, v9
v_mul_f32 v43, v121, v9
v_mul_f32 v51, v125, v9
v_fract_f32 v27, v27
v_fract_f32 v35, v35
v_fract_f32 v43, v43
v_fract_f32 v51, v51
v_cos_f32 v24, v27
v_cos_f32 v32, v35
v_cos_f32 v40, v43
v_cos_f32 v48, v51
v_sin_f32 v25, v27
v_sin_f32 v33, v35
v_sin_f32 v41, v43
v_sin_f32 v49, v51
v_mul_f32 v24, v24, v26
v_mul_f32 v32, v32, v34
v_mul_f32 v40, v40, v42
v_mul_f32 v48, v48, v50
v_mul_f32 v25, v25, v26
v_mul_f32 v33, v33, v34
v_mul_f32 v41, v41, v42
v_mul_f32 v49, v49, v50
v_mul_f32 v28, v114, v24
v_mul_f32 v36, v118, v32
v_mul_f32 v44, v122, v40
v_mul_f32 v52, v126, v48
v_fma_f32 v28, -v115, v25, v28
v_fma_f32 v36, -v119, v33, v36
v_fma_f32 v44, -v123, v41, v44
v_fma_f32 v52, -v127, v49, v52
v_mul_f32 v29, v114, v25
v_mul_f32 v37, v118, v33
v_mul_f32 v45, v122, v41
v_mul_f32 v53, v126, v49
v_fma_f32 v29, v115, v24, v29
v_fma_f32 v37, v119, v32, v37
v_fma_f32 v45, v123, v40, v45
v_fma_f32 v53, v127, v48, v53
v_cvt_pk_bf16_f32 v16, v28, -v29
v_cvt_pk_bf16_f32 v17, v36, -v37
v_cvt_pk_bf16_f32 v18, v44, -v45
v_cvt_pk_bf16_f32 v19, v52, -v53
s_nop 1
v_mfma_f32_16x16x32_bf16 v[12:15], v[16:19], v[20:23], v[12:15]
s_nop 3
ds_read_b128 v[64:67], v11 offset:256
ds_read_b128 v[68:71], v11 offset:272
ds_read_b128 v[72:75], v11 offset:288
ds_read_b128 v[76:79], v11 offset:304
ds_read_b128 v[80:83], v11 offset:320
ds_read_b128 v[84:87], v11 offset:336
ds_read_b128 v[88:91], v11 offset:352
ds_read_b128 v[92:95], v11 offset:368
ds_read_b128 v[96:99], v11 offset:384
ds_read_b128 v[100:103], v11 offset:400
ds_read_b128 v[104:107], v11 offset:416
ds_read_b128 v[108:111], v11 offset:432
ds_read_b128 v[112:115], v11 offset:448
ds_read_b128 v[116:119], v11 offset:464
ds_read_b128 v[120:123], v11 offset:480
ds_read_b128 v[124:127], v11 offset:496
s_waitcnt lgkmcnt(0)
v_mul_f32 v26, v64, v8
v_mul_f32 v34, v68, v8
v_mul_f32 v42, v72, v8
v_mul_f32 v50, v76, v8
v_exp_f32 v26, v26
v_exp_f32 v34, v34
v_exp_f32 v42, v42
v_exp_f32 v50, v50
v_mul_f32 v27, v65, v8
v_mul_f32 v35, v69, v8
v_mul_f32 v43, v73, v8
v_mul_f32 v51, v77, v8
v_fract_f32 v27, v27
v_fract_f32 v35, v35
v_fract_f32 v43, v43
v_fract_f32 v51, v51
v_cos_f32 v24, v27
v_cos_f32 v32, v35
v_cos_f32 v40, v43
v_cos_f32 v48, v51
v_sin_f32 v25, v27
v_sin_f32 v33, v35
v_sin_f32 v41, v43
v_sin_f32 v49, v51
v_mul_f32 v24, v24, v26
v_mul_f32 v32, v32, v34
v_mul_f32 v40, v40, v42
v_mul_f32 v48, v48, v50
v_mul_f32 v25, v25, v26
v_mul_f32 v33, v33, v34
v_mul_f32 v41, v41, v42
v_mul_f32 v49, v49, v50
v_cvt_pk_bf16_f32 v20, v24, v25
v_cvt_pk_bf16_f32 v21, v32, v33
v_cvt_pk_bf16_f32 v22, v40, v41
v_cvt_pk_bf16_f32 v23, v48, v49
v_mul_f32 v26, v64, v9
v_mul_f32 v34, v68, v9
v_mul_f32 v42, v72, v9
v_mul_f32 v50, v76, v9
v_exp_f32 v26, v26
v_exp_f32 v34, v34
v_exp_f32 v42, v42
v_exp_f32 v50, v50
v_mul_f32 v27, v65, v9
v_mul_f32 v35, v69, v9
v_mul_f32 v43, v73, v9
v_mul_f32 v51, v77, v9
v_fract_f32 v27, v27
v_fract_f32 v35, v35
v_fract_f32 v43, v43
v_fract_f32 v51, v51
v_cos_f32 v24, v27
v_cos_f32 v32, v35
v_cos_f32 v40, v43
v_cos_f32 v48, v51
v_sin_f32 v25, v27
v_sin_f32 v33, v35
v_sin_f32 v41, v43
v_sin_f32 v49, v51
v_mul_f32 v24, v24, v26
v_mul_f32 v32, v32, v34
v_mul_f32 v40, v40, v42
v_mul_f32 v48, v48, v50
v_mul_f32 v25, v25, v26
v_mul_f32 v33, v33, v34
v_mul_f32 v41, v41, v42
v_mul_f32 v49, v49, v50
v_mul_f32 v28, v66, v24
v_mul_f32 v36, v70, v32
v_mul_f32 v44, v74, v40
v_mul_f32 v52, v78, v48
v_fma_f32 v28, -v67, v25, v28
v_fma_f32 v36, -v71, v33, v36
v_fma_f32 v44, -v75, v41, v44
v_fma_f32 v52, -v79, v49, v52
v_mul_f32 v29, v66, v25
v_mul_f32 v37, v70, v33
v_mul_f32 v45, v74, v41
v_mul_f32 v53, v78, v49
v_fma_f32 v29, v67, v24, v29
v_fma_f32 v37, v71, v32, v37
v_fma_f32 v45, v75, v40, v45
v_fma_f32 v53, v79, v48, v53
v_cvt_pk_bf16_f32 v16, v28, -v29
v_cvt_pk_bf16_f32 v17, v36, -v37
v_cvt_pk_bf16_f32 v18, v44, -v45
v_cvt_pk_bf16_f32 v19, v52, -v53
s_nop 1
v_mfma_f32_16x16x32_bf16 v[12:15], v[16:19], v[20:23], v[12:15]
s_nop 3
v_mul_f32 v26, v80, v8
v_mul_f32 v34, v84, v8
v_mul_f32 v42, v88, v8
v_mul_f32 v50, v92, v8
v_exp_f32 v26, v26
v_exp_f32 v34, v34
v_exp_f32 v42, v42
v_exp_f32 v50, v50
v_mul_f32 v27, v81, v8
v_mul_f32 v35, v85, v8
v_mul_f32 v43, v89, v8
v_mul_f32 v51, v93, v8
v_fract_f32 v27, v27
v_fract_f32 v35, v35
v_fract_f32 v43, v43
v_fract_f32 v51, v51
v_cos_f32 v24, v27
v_cos_f32 v32, v35
v_cos_f32 v40, v43
v_cos_f32 v48, v51
v_sin_f32 v25, v27
v_sin_f32 v33, v35
v_sin_f32 v41, v43
v_sin_f32 v49, v51
v_mul_f32 v24, v24, v26
v_mul_f32 v32, v32, v34
v_mul_f32 v40, v40, v42
v_mul_f32 v48, v48, v50
v_mul_f32 v25, v25, v26
v_mul_f32 v33, v33, v34
v_mul_f32 v41, v41, v42
v_mul_f32 v49, v49, v50
v_cvt_pk_bf16_f32 v20, v24, v25
v_cvt_pk_bf16_f32 v21, v32, v33
v_cvt_pk_bf16_f32 v22, v40, v41
v_cvt_pk_bf16_f32 v23, v48, v49
v_mul_f32 v26, v80, v9
v_mul_f32 v34, v84, v9
v_mul_f32 v42, v88, v9
v_mul_f32 v50, v92, v9
v_exp_f32 v26, v26
v_exp_f32 v34, v34
v_exp_f32 v42, v42
v_exp_f32 v50, v50
v_mul_f32 v27, v81, v9
v_mul_f32 v35, v85, v9
v_mul_f32 v43, v89, v9
v_mul_f32 v51, v93, v9
v_fract_f32 v27, v27
v_fract_f32 v35, v35
v_fract_f32 v43, v43
v_fract_f32 v51, v51
v_cos_f32 v24, v27
v_cos_f32 v32, v35
v_cos_f32 v40, v43
v_cos_f32 v48, v51
v_sin_f32 v25, v27
v_sin_f32 v33, v35
v_sin_f32 v41, v43
v_sin_f32 v49, v51
v_mul_f32 v24, v24, v26
v_mul_f32 v32, v32, v34
v_mul_f32 v40, v40, v42
v_mul_f32 v48, v48, v50
v_mul_f32 v25, v25, v26
v_mul_f32 v33, v33, v34
v_mul_f32 v41, v41, v42
v_mul_f32 v49, v49, v50
v_mul_f32 v28, v82, v24
v_mul_f32 v36, v86, v32
v_mul_f32 v44, v90, v40
v_mul_f32 v52, v94, v48
v_fma_f32 v28, -v83, v25, v28
v_fma_f32 v36, -v87, v33, v36
v_fma_f32 v44, -v91, v41, v44
v_fma_f32 v52, -v95, v49, v52
v_mul_f32 v29, v82, v25
v_mul_f32 v37, v86, v33
v_mul_f32 v45, v90, v41
v_mul_f32 v53, v94, v49
v_fma_f32 v29, v83, v24, v29
v_fma_f32 v37, v87, v32, v37
v_fma_f32 v45, v91, v40, v45
v_fma_f32 v53, v95, v48, v53
v_cvt_pk_bf16_f32 v16, v28, -v29
v_cvt_pk_bf16_f32 v17, v36, -v37
v_cvt_pk_bf16_f32 v18, v44, -v45
v_cvt_pk_bf16_f32 v19, v52, -v53
s_nop 1
v_mfma_f32_16x16x32_bf16 v[12:15], v[16:19], v[20:23], v[12:15]
s_nop 3
v_mul_f32 v26, v96, v8
v_mul_f32 v34, v100, v8
v_mul_f32 v42, v104, v8
v_mul_f32 v50, v108, v8
v_exp_f32 v26, v26
v_exp_f32 v34, v34
v_exp_f32 v42, v42
v_exp_f32 v50, v50
v_mul_f32 v27, v97, v8
v_mul_f32 v35, v101, v8
v_mul_f32 v43, v105, v8
v_mul_f32 v51, v109, v8
v_fract_f32 v27, v27
v_fract_f32 v35, v35
v_fract_f32 v43, v43
v_fract_f32 v51, v51
v_cos_f32 v24, v27
v_cos_f32 v32, v35
v_cos_f32 v40, v43
v_cos_f32 v48, v51
v_sin_f32 v25, v27
v_sin_f32 v33, v35
v_sin_f32 v41, v43
v_sin_f32 v49, v51
v_mul_f32 v24, v24, v26
v_mul_f32 v32, v32, v34
v_mul_f32 v40, v40, v42
v_mul_f32 v48, v48, v50
v_mul_f32 v25, v25, v26
v_mul_f32 v33, v33, v34
v_mul_f32 v41, v41, v42
v_mul_f32 v49, v49, v50
v_cvt_pk_bf16_f32 v20, v24, v25
v_cvt_pk_bf16_f32 v21, v32, v33
v_cvt_pk_bf16_f32 v22, v40, v41
v_cvt_pk_bf16_f32 v23, v48, v49
v_mul_f32 v26, v96, v9
v_mul_f32 v34, v100, v9
v_mul_f32 v42, v104, v9
v_mul_f32 v50, v108, v9
v_exp_f32 v26, v26
v_exp_f32 v34, v34
v_exp_f32 v42, v42
v_exp_f32 v50, v50
v_mul_f32 v27, v97, v9
v_mul_f32 v35, v101, v9
v_mul_f32 v43, v105, v9
v_mul_f32 v51, v109, v9
v_fract_f32 v27, v27
v_fract_f32 v35, v35
v_fract_f32 v43, v43
v_fract_f32 v51, v51
v_cos_f32 v24, v27
v_cos_f32 v32, v35
v_cos_f32 v40, v43
v_cos_f32 v48, v51
v_sin_f32 v25, v27
v_sin_f32 v33, v35
v_sin_f32 v41, v43
v_sin_f32 v49, v51
v_mul_f32 v24, v24, v26
v_mul_f32 v32, v32, v34
v_mul_f32 v40, v40, v42
v_mul_f32 v48, v48, v50
v_mul_f32 v25, v25, v26
v_mul_f32 v33, v33, v34
v_mul_f32 v41, v41, v42
v_mul_f32 v49, v49, v50
v_mul_f32 v28, v98, v24
v_mul_f32 v36, v102, v32
v_mul_f32 v44, v106, v40
v_mul_f32 v52, v110, v48
v_fma_f32 v28, -v99, v25, v28
v_fma_f32 v36, -v103, v33, v36
v_fma_f32 v44, -v107, v41, v44
v_fma_f32 v52, -v111, v49, v52
v_mul_f32 v29, v98, v25
v_mul_f32 v37, v102, v33
v_mul_f32 v45, v106, v41
v_mul_f32 v53, v110, v49
v_fma_f32 v29, v99, v24, v29
v_fma_f32 v37, v103, v32, v37
v_fma_f32 v45, v107, v40, v45
v_fma_f32 v53, v111, v48, v53
v_cvt_pk_bf16_f32 v16, v28, -v29
v_cvt_pk_bf16_f32 v17, v36, -v37
v_cvt_pk_bf16_f32 v18, v44, -v45
v_cvt_pk_bf16_f32 v19, v52, -v53
s_nop 1
v_mfma_f32_16x16x32_bf16 v[12:15], v[16:19], v[20:23], v[12:15]
s_nop 3
v_mul_f32 v26, v112, v8
v_mul_f32 v34, v116, v8
v_mul_f32 v42, v120, v8
v_mul_f32 v50, v124, v8
v_exp_f32 v26, v26
v_exp_f32 v34, v34
v_exp_f32 v42, v42
v_exp_f32 v50, v50
v_mul_f32 v27, v113, v8
v_mul_f32 v35, v117, v8
v_mul_f32 v43, v121, v8
v_mul_f32 v51, v125, v8
v_fract_f32 v27, v27
v_fract_f32 v35, v35
v_fract_f32 v43, v43
v_fract_f32 v51, v51
v_cos_f32 v24, v27
v_cos_f32 v32, v35
v_cos_f32 v40, v43
v_cos_f32 v48, v51
v_sin_f32 v25, v27
v_sin_f32 v33, v35
v_sin_f32 v41, v43
v_sin_f32 v49, v51
v_mul_f32 v24, v24, v26
v_mul_f32 v32, v32, v34
v_mul_f32 v40, v40, v42
v_mul_f32 v48, v48, v50
v_mul_f32 v25, v25, v26
v_mul_f32 v33, v33, v34
v_mul_f32 v41, v41, v42
v_mul_f32 v49, v49, v50
v_cvt_pk_bf16_f32 v20, v24, v25
v_cvt_pk_bf16_f32 v21, v32, v33
v_cvt_pk_bf16_f32 v22, v40, v41
v_cvt_pk_bf16_f32 v23, v48, v49
v_mul_f32 v26, v112, v9
v_mul_f32 v34, v116, v9
v_mul_f32 v42, v120, v9
v_mul_f32 v50, v124, v9
v_exp_f32 v26, v26
v_exp_f32 v34, v34
v_exp_f32 v42, v42
v_exp_f32 v50, v50
v_mul_f32 v27, v113, v9
v_mul_f32 v35, v117, v9
v_mul_f32 v43, v121, v9
v_mul_f32 v51, v125, v9
v_fract_f32 v27, v27
v_fract_f32 v35, v35
v_fract_f32 v43, v43
v_fract_f32 v51, v51
v_cos_f32 v24, v27
v_cos_f32 v32, v35
v_cos_f32 v40, v43
v_cos_f32 v48, v51
v_sin_f32 v25, v27
v_sin_f32 v33, v35
v_sin_f32 v41, v43
v_sin_f32 v49, v51
v_mul_f32 v24, v24, v26
v_mul_f32 v32, v32, v34
v_mul_f32 v40, v40, v42
v_mul_f32 v48, v48, v50
v_mul_f32 v25, v25, v26
v_mul_f32 v33, v33, v34
v_mul_f32 v41, v41, v42
v_mul_f32 v49, v49, v50
v_mul_f32 v28, v114, v24
v_mul_f32 v36, v118, v32
v_mul_f32 v44, v122, v40
v_mul_f32 v52, v126, v48
v_fma_f32 v28, -v115, v25, v28
v_fma_f32 v36, -v119, v33, v36
v_fma_f32 v44, -v123, v41, v44
v_fma_f32 v52, -v127, v49, v52
v_mul_f32 v29, v114, v25
v_mul_f32 v37, v118, v33
v_mul_f32 v45, v122, v41
v_mul_f32 v53, v126, v49
v_fma_f32 v29, v115, v24, v29
v_fma_f32 v37, v119, v32, v37
v_fma_f32 v45, v123, v40, v45
v_fma_f32 v53, v127, v48, v53
v_cvt_pk_bf16_f32 v16, v28, -v29
v_cvt_pk_bf16_f32 v17, v36, -v37
v_cvt_pk_bf16_f32 v18, v44, -v45
v_cvt_pk_bf16_f32 v19, v52, -v53
s_nop 1
v_mfma_f32_16x16x32_bf16 v[12:15], v[16:19], v[20:23], v[12:15]
s_nop 3
s_nop 7
v_lshlrev_b32 v16, 7, v1
v_add_u32 v16, 128, v16
v_cmp_eq_u32 vcc, 0, v1
s_nop 1
v_cndmask_b32 v16, v16, 0, vcc
v_lshl_add_u32 v16, v3, 6, v16
v_add_u32 v16, v16, v2
v_lshlrev_b32 v16, 2, v16
s_mul_i32 s30, s3, 2688
s_add_u32 s30, s30, 8388608
v_cmp_gt_u32 vcc, 2, v3
v_cmp_eq_u32 s[36:37], 0, v1
s_or_b64 s[36:37], s[36:37], vcc
v_cmp_eq_u32 vcc, 3, v1
v_cmp_eq_u32 s[38:39], 2, v3
s_and_b64 s[38:39], s[38:39], vcc
s_or_b64 s[38:39], s[38:39], s[36:37]
s_mov_b64 exec, s[38:39]
buffer_store_dword v12, v16, s[8:11], s30 offen
s_mov_b64 exec, s[36:37]
buffer_store_dword v13, v16, s[8:11], s30 offen offset:64
buffer_store_dword v14, v16, s[8:11], s30 offen offset:128
buffer_store_dword v15, v16, s[8:11], s30 offen offset:192
s_mov_b64 exec, -1
s_branch prep_end
prep_trans:
s_sub_u32 s3, s2, 768
s_load_dwordx2 s[6:7], s[0:1], 80
s_load_dwordx2 s[16:17], s[0:1], 96
s_waitcnt lgkmcnt(0)
s_cmp_ge_u32 s3, 224
s_cbranch_scc1 tr_w2
s_mul_i32 s18, s3, 9363
s_lshr_b32 s18, s18, 18
s_mul_i32 s19, s18, 28
s_sub_u32 s19, s3, s19
s_mov_b32 s20, 3584
s_mov_b32 s21, 1024
s_mov_b32 s22, 4194304
s_mov_b32 s12, s6
s_and_b32 s13, s7, 0xffff
s_mov_b32 s14, 1835008
s_mov_b32 s15, 0x00020000
s_branch tr_go
tr_w2:
s_sub_u32 s3, s3, 224
s_lshr_b32 s18, s3, 3
s_and_b32 s19, s3, 7
s_mov_b32 s20, 1024
s_mov_b32 s21, 3584
s_mov_b32 s22, 6291456
s_mov_b32 s12, s16
s_and_b32 s13, s17, 0xffff
s_mov_b32 s14, 1835008
s_mov_b32 s15, 0x00020000
tr_go:
v_lshrrev_b32 v1, 3, v0
v_and_b32 v2, 7, v0
s_lshl_b32 s23, s18, 6
s_mul_i32 s23, s23, s20
s_lshl_b32 s24, s19, 7
s_add_u32 s23, s23, s24
v_mul_lo_u32 v3, v1, s20
v_lshl_add_u32 v3, v2, 4, v3
v_add_u32 v3, s23, v3
s_lshl_b32 s25, s20, 5
v_add_u32 v4, s25, v3
buffer_load_dwordx4 v[8:11], v3, s[12:15], 0 offen
buffer_load_dwordx4 v[12:15], v4, s[12:15], 0 offen
v_mul_u32_u24 v5, 136, v1
v_lshl_add_u32 v5, v2, 4, v5
s_waitcnt vmcnt(0)
ds_write_b64 v5, v[8:9]
ds_write_b64 v5, v[10:11] offset:8
ds_write_b64 v5, v[12:13] offset:4352
ds_write_b64 v5, v[14:15] offset:4360
s_waitcnt lgkmcnt(0)
s_barrier
s_lshl_b32 s23, s19, 6
s_mul_i32 s23, s23, s21
s_lshl_b32 s24, s18, 7
s_add_u32 s23, s23, s24
s_add_u32 s23, s23, s22
s_lshl_b32 s26, s21, 5
v_mul_u32_u24 v5, 1088, v2
v_lshl_add_u32 v5, v1, 1, v5
ds_read_u16 v16, v5 offset:0
ds_read_u16 v17, v5 offset:136
ds_read_u16 v18, v5 offset:272
ds_read_u16 v19, v5 offset:408
ds_read_u16 v20, v5 offset:544
ds_read_u16 v21, v5 offset:680
ds_read_u16 v22, v5 offset:816
ds_read_u16 v23, v5 offset:952
s_waitcnt lgkmcnt(0)
v_lshl_or_b32 v24, v17, 16, v16
v_lshl_or_b32 v25, v19, 16, v18
v_lshl_or_b32 v26, v21, 16, v20
v_lshl_or_b32 v27, v23, 16, v22
v_mul_lo_u32 v6, v1, s21
v_lshl_add_u32 v6, v2, 4, v6
buffer_store_dwordx4 v[24:27], v6, s[8:11], s23 offen
s_nop 1
v_mul_u32_u24 v5, 1088, v2
v_lshl_add_u32 v5, v1, 1, v5
ds_read_u16 v16, v5 offset:64
ds_read_u16 v17, v5 offset:200
ds_read_u16 v18, v5 offset:336
ds_read_u16 v19, v5 offset:472
ds_read_u16 v20, v5 offset:608
ds_read_u16 v21, v5 offset:744
ds_read_u16 v22, v5 offset:880
ds_read_u16 v23, v5 offset:1016
s_waitcnt lgkmcnt(0)
v_lshl_or_b32 v24, v17, 16, v16
v_lshl_or_b32 v25, v19, 16, v18
v_lshl_or_b32 v26, v21, 16, v20
v_lshl_or_b32 v27, v23, 16, v22
v_mul_lo_u32 v6, v1, s21
v_lshl_add_u32 v6, v2, 4, v6
v_add_u32 v6, s26, v6
buffer_store_dwordx4 v[24:27], v6, s[8:11], s23 offen
s_nop 1
prep_end:
s_endpgm
.p2align 8
mid_kernel:
s_cmp_ge_u32 s2, 480
s_cbranch_scc1 mid_end
s_load_dwordx2 s[4:5], s[0:1], 128
s_waitcnt lgkmcnt(0)
s_mov_b32 s8, s4
s_and_b32 s9, s5, 0xffff
s_mov_b32 s10, 33554432
s_mov_b32 s11, 0x00020000
s_cmp_ge_u32 s2, 224
s_cbranch_scc1 mid_conv
s_and_b32 s12, s2, 7
s_lshl_b32 s12, s12, 1
s_lshr_b32 s13, s2, 3
s_cmp_ge_u32 s13, 14
s_cselect_b32 s16, 1, 0
s_cselect_b32 s17, 14, 0
s_add_u32 s12, s12, s16
s_sub_u32 s13, s13, s17
s_lshl_b32 s14, s12, 17
s_add_u32 s14, s14, 0
s_lshl_b32 s15, s13, 17
s_add_u32 s15, s15, 4194304
v_lshrrev_b32 v5, 6, v0
v_and_b32 v6, 31, v0
v_bfe_u32 v7, v0, 5, 1
v_lshrrev_b32 v8, 1, v5
v_and_b32 v9, 1, v5
v_bfe_u32 v1, v0, 2, 4
v_lshl_add_u32 v1, v5, 5, v1
v_and_b32 v2, 3, v0
v_bfe_u32 v4, v0, 4, 2
v_xor_b32 v2, v2, v4
v_lshlrev_b32 v3, 10, v1
v_lshl_add_u32 v3, v2, 4, v3
v_readfirstlane_b32 s36, v5
s_nop 3
s_lshl_b32 s36, s36, 11
v_bfe_u32 v1, v0, 2, 2
v_xor_b32 v1, v1, v7
v_lshl_add_u32 v2, v8, 6, v6
v_lshlrev_b32 v2, 6, v2
v_lshl_add_u32 v4, v9, 6, v6
v_lshlrev_b32 v4, 6, v4
v_add_u32 v4, 8192, v4
v_xor_b32 v10, 0, v1
v_lshl_add_u32 v144, v10, 4, v2
v_lshl_add_u32 v146, v10, 4, v4
v_xor_b32 v10, 2, v1
v_lshl_add_u32 v145, v10, 4, v2
v_lshl_add_u32 v147, v10, 4, v4
v_mov_b32 v64, 0
v_mov_b32 v65, 0
v_mov_b32 v66, 0
v_mov_b32 v67, 0
v_mov_b32 v68, 0
v_mov_b32 v69, 0
v_mov_b32 v70, 0
v_mov_b32 v71, 0
v_mov_b32 v72, 0
v_mov_b32 v73, 0
v_mov_b32 v74, 0
v_mov_b32 v75, 0
v_mov_b32 v76, 0
v_mov_b32 v77, 0
v_mov_b32 v78, 0
v_mov_b32 v79, 0
v_mov_b32 v80, 0
v_mov_b32 v81, 0
v_mov_b32 v82, 0
v_mov_b32 v83, 0
v_mov_b32 v84, 0
v_mov_b32 v85, 0
v_mov_b32 v86, 0
v_mov_b32 v87, 0
v_mov_b32 v88, 0
v_mov_b32 v89, 0
v_mov_b32 v90, 0
v_mov_b32 v91, 0
v_mov_b32 v92, 0
v_mov_b32 v93, 0
v_mov_b32 v94, 0
v_mov_b32 v95, 0
v_mov_b32 v96, 0
v_mov_b32 v97, 0
v_mov_b32 v98, 0
v_mov_b32 v99, 0
v_mov_b32 v100, 0
v_mov_b32 v101, 0
v_mov_b32 v102, 0
v_mov_b32 v103, 0
v_mov_b32 v104, 0
v_mov_b32 v105, 0
v_mov_b32 v106, 0
v_mov_b32 v107, 0
v_mov_b32 v108, 0
v_mov_b32 v109, 0
v_mov_b32 v110, 0
v_mov_b32 v111, 0
v_mov_b32 v112, 0
v_mov_b32 v113, 0
v_mov_b32 v114, 0
v_mov_b32 v115, 0
v_mov_b32 v116, 0
v_mov_b32 v117, 0
v_mov_b32 v118, 0
v_mov_b32 v119, 0
v_mov_b32 v120, 0
v_mov_b32 v121, 0
v_mov_b32 v122, 0
v_mov_b32 v123, 0
v_mov_b32 v124, 0
v_mov_b32 v125, 0
v_mov_b32 v126, 0
v_mov_b32 v127, 0
s_load_dwordx2 s[6:7], s[0:1], 88
s_waitcnt lgkmcnt(0)
s_mov_b32 s24, s6
s_and_b32 s25, s7, 0xffff
s_mov_b32 s26, 3584
s_mov_b32 s27, 0x00020000
s_lshl_b32 s20, s13, 8
v_lshlrev_b32 v12, 7, v9
v_lshl_add_u32 v12, v7, 3, v12
v_add_u32 v12, s20, v12
v_lshl_add_u32 v13, v8, 6, v6
s_mov_b32 s21, 3584
v_mul_lo_u32 v13, v13, s21
v_add_u32 v13, v13, v12
s_mul_i32 s22, s12, 458752
s_add_u32 s22, s22, 10485760
buffer_load_dwordx2 v[32:33], v12, s[24:27], 0 offen offset:0
buffer_load_dwordx2 v[34:35], v12, s[24:27], 0 offen offset:16
buffer_load_dwordx2 v[36:37], v12, s[24:27], 0 offen offset:32
buffer_load_dwordx2 v[38:39], v12, s[24:27], 0 offen offset:48
buffer_load_dwordx2 v[40:41], v12, s[24:27], 0 offen offset:64
buffer_load_dwordx2 v[42:43], v12, s[24:27], 0 offen offset:80
buffer_load_dwordx2 v[44:45], v12, s[24:27], 0 offen offset:96
buffer_load_dwordx2 v[46:47], v12, s[24:27], 0 offen offset:112
s_add_u32 s16, s14, 0
s_add_u32 s37, s36, 0
s_mov_b32 m0, s37
s_nop 0
buffer_load_dwordx4 v3, s[8:11], s16 offen lds
s_add_u32 s16, s14, 16384
s_add_u32 s37, s36, 1024
s_mov_b32 m0, s37
s_nop 0
buffer_load_dwordx4 v3, s[8:11], s16 offen lds
s_add_u32 s16, s15, 0
s_add_u32 s37, s36, 8192
s_mov_b32 m0, s37
s_nop 0
buffer_load_dwordx4 v3, s[8:11], s16 offen lds
s_add_u32 s16, s15, 16384
s_add_u32 s37, s36, 9216
s_mov_b32 m0, s37
s_nop 0
buffer_load_dwordx4 v3, s[8:11], s16 offen lds
s_add_u32 s16, s14, 64
s_add_u32 s37, s36, 16384
s_mov_b32 m0, s37
s_nop 0
buffer_load_dwordx4 v3, s[8:11], s16 offen lds
s_add_u32 s16, s14, 16448
s_add_u32 s37, s36, 17408
s_mov_b32 m0, s37
s_nop 0
buffer_load_dwordx4 v3, s[8:11], s16 offen lds
s_add_u32 s16, s15, 64
s_add_u32 s37, s36, 24576
s_mov_b32 m0, s37
s_nop 0
buffer_load_dwordx4 v3, s[8:11], s16 offen lds
s_add_u32 s16, s15, 16448
s_add_u32 s37, s36, 25600
s_mov_b32 m0, s37
s_nop 0
buffer_load_dwordx4 v3, s[8:11], s16 offen lds
s_add_u32 s16, s14, 128
s_add_u32 s37, s36, 32768
s_mov_b32 m0, s37
s_nop 0
buffer_load_dwordx4 v3, s[8:11], s16 offen lds
s_add_u32 s16, s14, 16512
s_add_u32 s37, s36, 33792
s_mov_b32 m0, s37
s_nop 0
buffer_load_dwordx4 v3, s[8:11], s16 offen lds
s_add_u32 s16, s15, 128
s_add_u32 s37, s36, 40960
s_mov_b32 m0, s37
s_nop 0
buffer_load_dwordx4 v3, s[8:11], s16 offen lds
s_add_u32 s16, s15, 16512
s_add_u32 s37, s36, 41984
s_mov_b32 m0, s37
s_nop 0
buffer_load_dwordx4 v3, s[8:11], s16 offen lds
s_waitcnt vmcnt(8)
s_barrier
s_add_u32 s16, s14, 192
s_add_u32 s37, s36, 49152
s_mov_b32 m0, s37
s_nop 0
buffer_load_dwordx4 v3, s[8:11], s16 offen lds
s_add_u32 s16, s14, 16576
s_add_u32 s37, s36, 50176
s_mov_b32 m0, s37
s_nop 0
buffer_load_dwordx4 v3, s[8:11], s16 offen lds
s_add_u32 s16, s15, 192
s_add_u32 s37, s36, 57344
s_mov_b32 m0, s37
s_nop 0
buffer_load_dwordx4 v3, s[8:11], s16 offen lds
s_add_u32 s16, s15, 16576
s_add_u32 s37, s36, 58368
s_mov_b32 m0, s37
s_nop 0
buffer_load_dwordx4 v3, s[8:11], s16 offen lds
ds_read_b128 v[48:51], v144 offset:0
ds_read_b128 v[52:55], v144 offset:2048
ds_read_b128 v[56:59], v146 offset:0
ds_read_b128 v[60:63], v146 offset:2048
ds_read_b128 v[128:131], v145 offset:0
ds_read_b128 v[132:135], v145 offset:2048
ds_read_b128 v[136:139], v147 offset:0
ds_read_b128 v[140:143], v147 offset:2048
s_waitcnt lgkmcnt(4)
v_mfma_f32_32x32x16_bf16 v[64:79], v[56:59], v[48:51], v[64:79]
v_mfma_f32_32x32x16_bf16 v[80:95], v[56:59], v[52:55], v[80:95]
v_mfma_f32_32x32x16_bf16 v[96:111], v[60:63], v[48:51], v[96:111]
v_mfma_f32_32x32x16_bf16 v[112:127], v[60:63], v[52:55], v[112:127]
s_waitcnt lgkmcnt(0)
v_mfma_f32_32x32x16_bf16 v[64:79], v[136:139], v[128:131], v[64:79]
v_mfma_f32_32x32x16_bf16 v[80:95], v[136:139], v[132:135], v[80:95]
v_mfma_f32_32x32x16_bf16 v[96:111], v[140:143], v[128:131], v[96:111]
v_mfma_f32_32x32x16_bf16 v[112:127], v[140:143], v[132:135], v[112:127]
s_waitcnt vmcnt(8)
s_barrier
s_add_u32 s16, s14, 256
s_add_u32 s37, s36, 0
s_mov_b32 m0, s37
s_nop 0
buffer_load_dwordx4 v3, s[8:11], s16 offen lds
s_add_u32 s16, s14, 16640
s_add_u32 s37, s36, 1024
s_mov_b32 m0, s37
s_nop 0
buffer_load_dwordx4 v3, s[8:11], s16 offen lds
s_add_u32 s16, s15, 256
s_add_u32 s37, s36, 8192
s_mov_b32 m0, s37
s_nop 0
buffer_load_dwordx4 v3, s[8:11], s16 offen lds
s_add_u32 s16, s15, 16640
s_add_u32 s37, s36, 9216
s_mov_b32 m0, s37
s_nop 0
buffer_load_dwordx4 v3, s[8:11], s16 offen lds
ds_read_b128 v[48:51], v144 offset:16384
ds_read_b128 v[52:55], v144 offset:18432
ds_read_b128 v[56:59], v146 offset:16384
ds_read_b128 v[60:63], v146 offset:18432
ds_read_b128 v[128:131], v145 offset:16384
ds_read_b128 v[132:135], v145 offset:18432
ds_read_b128 v[136:139], v147 offset:16384
ds_read_b128 v[140:143], v147 offset:18432
s_waitcnt lgkmcnt(4)
v_mfma_f32_32x32x16_bf16 v[64:79], v[56:59], v[48:51], v[64:79]
v_mfma_f32_32x32x16_bf16 v[80:95], v[56:59], v[52:55], v[80:95]
v_mfma_f32_32x32x16_bf16 v[96:111], v[60:63], v[48:51], v[96:111]
v_mfma_f32_32x32x16_bf16 v[112:127], v[60:63], v[52:55], v[112:127]
s_waitcnt lgkmcnt(0)
v_mfma_f32_32x32x16_bf16 v[64:79], v[136:139], v[128:131], v[64:79]
v_mfma_f32_32x32x16_bf16 v[80:95], v[136:139], v[132:135], v[80:95]
v_mfma_f32_32x32x16_bf16 v[96:111], v[140:143], v[128:131], v[96:111]
v_mfma_f32_32x32x16_bf16 v[112:127], v[140:143], v[132:135], v[112:127]
s_waitcnt vmcnt(8)
s_barrier
s_add_u32 s16, s14, 320
s_add_u32 s37, s36, 16384
s_mov_b32 m0, s37
s_nop 0
buffer_load_dwordx4 v3, s[8:11], s16 offen lds
s_add_u32 s16, s14, 16704
s_add_u32 s37, s36, 17408
s_mov_b32 m0, s37
s_nop 0
buffer_load_dwordx4 v3, s[8:11], s16 offen lds
s_add_u32 s16, s15, 320
s_add_u32 s37, s36, 24576
s_mov_b32 m0, s37
s_nop 0
buffer_load_dwordx4 v3, s[8:11], s16 offen lds
s_add_u32 s16, s15, 16704
s_add_u32 s37, s36, 25600
s_mov_b32 m0, s37
s_nop 0
buffer_load_dwordx4 v3, s[8:11], s16 offen lds
ds_read_b128 v[48:51], v144 offset:32768
ds_read_b128 v[52:55], v144 offset:34816
ds_read_b128 v[56:59], v146 offset:32768
ds_read_b128 v[60:63], v146 offset:34816
ds_read_b128 v[128:131], v145 offset:32768
ds_read_b128 v[132:135], v145 offset:34816
ds_read_b128 v[136:139], v147 offset:32768
ds_read_b128 v[140:143], v147 offset:34816
s_waitcnt lgkmcnt(4)
v_mfma_f32_32x32x16_bf16 v[64:79], v[56:59], v[48:51], v[64:79]
v_mfma_f32_32x32x16_bf16 v[80:95], v[56:59], v[52:55], v[80:95]
v_mfma_f32_32x32x16_bf16 v[96:111], v[60:63], v[48:51], v[96:111]
v_mfma_f32_32x32x16_bf16 v[112:127], v[60:63], v[52:55], v[112:127]
s_waitcnt lgkmcnt(0)
v_mfma_f32_32x32x16_bf16 v[64:79], v[136:139], v[128:131], v[64:79]
v_mfma_f32_32x32x16_bf16 v[80:95], v[136:139], v[132:135], v[80:95]
v_mfma_f32_32x32x16_bf16 v[96:111], v[140:143], v[128:131], v[96:111]
v_mfma_f32_32x32x16_bf16 v[112:127], v[140:143], v[132:135], v[112:127]
s_waitcnt vmcnt(8)
s_barrier
s_add_u32 s16, s14, 384
s_add_u32 s37, s36, 32768
s_mov_b32 m0, s37
s_nop 0
buffer_load_dwordx4 v3, s[8:11], s16 offen lds
s_add_u32 s16, s14, 16768
s_add_u32 s37, s36, 33792
s_mov_b32 m0, s37
s_nop 0
buffer_load_dwordx4 v3, s[8:11], s16 offen lds
s_add_u32 s16, s15, 384
s_add_u32 s37, s36, 40960
s_mov_b32 m0, s37
s_nop 0
buffer_load_dwordx4 v3, s[8:11], s16 offen lds
s_add_u32 s16, s15, 16768
s_add_u32 s37, s36, 41984
s_mov_b32 m0, s37
s_nop 0
buffer_load_dwordx4 v3, s[8:11], s16 offen lds
ds_read_b128 v[48:51], v144 offset:49152
ds_read_b128 v[52:55], v144 offset:51200
ds_read_b128 v[56:59], v146 offset:49152
ds_read_b128 v[60:63], v146 offset:51200
ds_read_b128 v[128:131], v145 offset:49152
ds_read_b128 v[132:135], v145 offset:51200
ds_read_b128 v[136:139], v147 offset:49152
ds_read_b128 v[140:143], v147 offset:51200
s_waitcnt lgkmcnt(4)
v_mfma_f32_32x32x16_bf16 v[64:79], v[56:59], v[48:51], v[64:79]
v_mfma_f32_32x32x16_bf16 v[80:95], v[56:59], v[52:55], v[80:95]
v_mfma_f32_32x32x16_bf16 v[96:111], v[60:63], v[48:51], v[96:111]
v_mfma_f32_32x32x16_bf16 v[112:127], v[60:63], v[52:55], v[112:127]
s_waitcnt lgkmcnt(0)
v_mfma_f32_32x32x16_bf16 v[64:79], v[136:139], v[128:131], v[64:79]
v_mfma_f32_32x32x16_bf16 v[80:95], v[136:139], v[132:135], v[80:95]
v_mfma_f32_32x32x16_bf16 v[96:111], v[140:143], v[128:131], v[96:111]
v_mfma_f32_32x32x16_bf16 v[112:127], v[140:143], v[132:135], v[112:127]
s_waitcnt vmcnt(8)
s_barrier
s_add_u32 s16, s14, 448
s_add_u32 s37, s36, 49152
s_mov_b32 m0, s37
s_nop 0
buffer_load_dwordx4 v3, s[8:11], s16 offen lds
s_add_u32 s16, s14, 16832
s_add_u32 s37, s36, 50176
s_mov_b32 m0, s37
s_nop 0
buffer_load_dwordx4 v3, s[8:11], s16 offen lds
s_add_u32 s16, s15, 448
s_add_u32 s37, s36, 57344
s_mov_b32 m0, s37
s_nop 0
buffer_load_dwordx4 v3, s[8:11], s16 offen lds
s_add_u32 s16, s15, 16832
s_add_u32 s37, s36, 58368
s_mov_b32 m0, s37
s_nop 0
buffer_load_dwordx4 v3, s[8:11], s16 offen lds
ds_read_b128 v[48:51], v144 offset:0
ds_read_b128 v[52:55], v144 offset:2048
ds_read_b128 v[56:59], v146 offset:0
ds_read_b128 v[60:63], v146 offset:2048
ds_read_b128 v[128:131], v145 offset:0
ds_read_b128 v[132:135], v145 offset:2048
ds_read_b128 v[136:139], v147 offset:0
ds_read_b128 v[140:143], v147 offset:2048
s_waitcnt lgkmcnt(4)
v_mfma_f32_32x32x16_bf16 v[64:79], v[56:59], v[48:51], v[64:79]
v_mfma_f32_32x32x16_bf16 v[80:95], v[56:59], v[52:55], v[80:95]
v_mfma_f32_32x32x16_bf16 v[96:111], v[60:63], v[48:51], v[96:111]
v_mfma_f32_32x32x16_bf16 v[112:127], v[60:63], v[52:55], v[112:127]
s_waitcnt lgkmcnt(0)
v_mfma_f32_32x32x16_bf16 v[64:79], v[136:139], v[128:131], v[64:79]
v_mfma_f32_32x32x16_bf16 v[80:95], v[136:139], v[132:135], v[80:95]
v_mfma_f32_32x32x16_bf16 v[96:111], v[140:143], v[128:131], v[96:111]
v_mfma_f32_32x32x16_bf16 v[112:127], v[140:143], v[132:135], v[112:127]
s_waitcnt vmcnt(8)
s_barrier
s_add_u32 s16, s14, 512
s_add_u32 s37, s36, 0
s_mov_b32 m0, s37
s_nop 0
buffer_load_dwordx4 v3, s[8:11], s16 offen lds
s_add_u32 s16, s14, 16896
s_add_u32 s37, s36, 1024
s_mov_b32 m0, s37
s_nop 0
buffer_load_dwordx4 v3, s[8:11], s16 offen lds
s_add_u32 s16, s15, 512
s_add_u32 s37, s36, 8192
s_mov_b32 m0, s37
s_nop 0
buffer_load_dwordx4 v3, s[8:11], s16 offen lds
s_add_u32 s16, s15, 16896
s_add_u32 s37, s36, 9216
s_mov_b32 m0, s37
s_nop 0
buffer_load_dwordx4 v3, s[8:11], s16 offen lds
ds_read_b128 v[48:51], v144 offset:16384
ds_read_b128 v[52:55], v144 offset:18432
ds_read_b128 v[56:59], v146 offset:16384
ds_read_b128 v[60:63], v146 offset:18432
ds_read_b128 v[128:131], v145 offset:16384
ds_read_b128 v[132:135], v145 offset:18432
ds_read_b128 v[136:139], v147 offset:16384
ds_read_b128 v[140:143], v147 offset:18432
s_waitcnt lgkmcnt(4)
v_mfma_f32_32x32x16_bf16 v[64:79], v[56:59], v[48:51], v[64:79]
v_mfma_f32_32x32x16_bf16 v[80:95], v[56:59], v[52:55], v[80:95]
v_mfma_f32_32x32x16_bf16 v[96:111], v[60:63], v[48:51], v[96:111]
v_mfma_f32_32x32x16_bf16 v[112:127], v[60:63], v[52:55], v[112:127]
s_waitcnt lgkmcnt(0)
v_mfma_f32_32x32x16_bf16 v[64:79], v[136:139], v[128:131], v[64:79]
v_mfma_f32_32x32x16_bf16 v[80:95], v[136:139], v[132:135], v[80:95]
v_mfma_f32_32x32x16_bf16 v[96:111], v[140:143], v[128:131], v[96:111]
v_mfma_f32_32x32x16_bf16 v[112:127], v[140:143], v[132:135], v[112:127]
s_waitcnt vmcnt(8)
s_barrier
s_add_u32 s16, s14, 576
s_add_u32 s37, s36, 16384
s_mov_b32 m0, s37
s_nop 0
buffer_load_dwordx4 v3, s[8:11], s16 offen lds
s_add_u32 s16, s14, 16960
s_add_u32 s37, s36, 17408
s_mov_b32 m0, s37
s_nop 0
buffer_load_dwordx4 v3, s[8:11], s16 offen lds
s_add_u32 s16, s15, 576
s_add_u32 s37, s36, 24576
s_mov_b32 m0, s37
s_nop 0
buffer_load_dwordx4 v3, s[8:11], s16 offen lds
s_add_u32 s16, s15, 16960
s_add_u32 s37, s36, 25600
s_mov_b32 m0, s37
s_nop 0
buffer_load_dwordx4 v3, s[8:11], s16 offen lds
ds_read_b128 v[48:51], v144 offset:32768
ds_read_b128 v[52:55], v144 offset:34816
ds_read_b128 v[56:59], v146 offset:32768
ds_read_b128 v[60:63], v146 offset:34816
ds_read_b128 v[128:131], v145 offset:32768
ds_read_b128 v[132:135], v145 offset:34816
ds_read_b128 v[136:139], v147 offset:32768
ds_read_b128 v[140:143], v147 offset:34816
s_waitcnt lgkmcnt(4)
v_mfma_f32_32x32x16_bf16 v[64:79], v[56:59], v[48:51], v[64:79]
v_mfma_f32_32x32x16_bf16 v[80:95], v[56:59], v[52:55], v[80:95]
v_mfma_f32_32x32x16_bf16 v[96:111], v[60:63], v[48:51], v[96:111]
v_mfma_f32_32x32x16_bf16 v[112:127], v[60:63], v[52:55], v[112:127]
s_waitcnt lgkmcnt(0)
v_mfma_f32_32x32x16_bf16 v[64:79], v[136:139], v[128:131], v[64:79]
v_mfma_f32_32x32x16_bf16 v[80:95], v[136:139], v[132:135], v[80:95]
v_mfma_f32_32x32x16_bf16 v[96:111], v[140:143], v[128:131], v[96:111]
v_mfma_f32_32x32x16_bf16 v[112:127], v[140:143], v[132:135], v[112:127]
s_waitcnt vmcnt(8)
s_barrier
s_add_u32 s16, s14, 640
s_add_u32 s37, s36, 32768
s_mov_b32 m0, s37
s_nop 0
buffer_load_dwordx4 v3, s[8:11], s16 offen lds
s_add_u32 s16, s14, 17024
s_add_u32 s37, s36, 33792
s_mov_b32 m0, s37
s_nop 0
buffer_load_dwordx4 v3, s[8:11], s16 offen lds
s_add_u32 s16, s15, 640
s_add_u32 s37, s36, 40960
s_mov_b32 m0, s37
s_nop 0
buffer_load_dwordx4 v3, s[8:11], s16 offen lds
s_add_u32 s16, s15, 17024
s_add_u32 s37, s36, 41984
s_mov_b32 m0, s37
s_nop 0
buffer_load_dwordx4 v3, s[8:11], s16 offen lds
ds_read_b128 v[48:51], v144 offset:49152
ds_read_b128 v[52:55], v144 offset:51200
ds_read_b128 v[56:59], v146 offset:49152
ds_read_b128 v[60:63], v146 offset:51200
ds_read_b128 v[128:131], v145 offset:49152
ds_read_b128 v[132:135], v145 offset:51200
ds_read_b128 v[136:139], v147 offset:49152
ds_read_b128 v[140:143], v147 offset:51200
s_waitcnt lgkmcnt(4)
v_mfma_f32_32x32x16_bf16 v[64:79], v[56:59], v[48:51], v[64:79]
v_mfma_f32_32x32x16_bf16 v[80:95], v[56:59], v[52:55], v[80:95]
v_mfma_f32_32x32x16_bf16 v[96:111], v[60:63], v[48:51], v[96:111]
v_mfma_f32_32x32x16_bf16 v[112:127], v[60:63], v[52:55], v[112:127]
s_waitcnt lgkmcnt(0)
v_mfma_f32_32x32x16_bf16 v[64:79], v[136:139], v[128:131], v[64:79]
v_mfma_f32_32x32x16_bf16 v[80:95], v[136:139], v[132:135], v[80:95]
v_mfma_f32_32x32x16_bf16 v[96:111], v[140:143], v[128:131], v[96:111]
v_mfma_f32_32x32x16_bf16 v[112:127], v[140:143], v[132:135], v[112:127]
s_waitcnt vmcnt(8)
s_barrier
s_add_u32 s16, s14, 704
s_add_u32 s37, s36, 49152
s_mov_b32 m0, s37
s_nop 0
buffer_load_dwordx4 v3, s[8:11], s16 offen lds
s_add_u32 s16, s14, 17088
s_add_u32 s37, s36, 50176
s_mov_b32 m0, s37
s_nop 0
buffer_load_dwordx4 v3, s[8:11], s16 offen lds
s_add_u32 s16, s15, 704
s_add_u32 s37, s36, 57344
s_mov_b32 m0, s37
s_nop 0
buffer_load_dwordx4 v3, s[8:11], s16 offen lds
s_add_u32 s16, s15, 17088
s_add_u32 s37, s36, 58368
s_mov_b32 m0, s37
s_nop 0
buffer_load_dwordx4 v3, s[8:11], s16 offen lds
ds_read_b128 v[48:51], v144 offset:0
ds_read_b128 v[52:55], v144 offset:2048
ds_read_b128 v[56:59], v146 offset:0
ds_read_b128 v[60:63], v146 offset:2048
ds_read_b128 v[128:131], v145 offset:0
ds_read_b128 v[132:135], v145 offset:2048
ds_read_b128 v[136:139], v147 offset:0
ds_read_b128 v[140:143], v147 offset:2048
s_waitcnt lgkmcnt(4)
v_mfma_f32_32x32x16_bf16 v[64:79], v[56:59], v[48:51], v[64:79]
v_mfma_f32_32x32x16_bf16 v[80:95], v[56:59], v[52:55], v[80:95]
v_mfma_f32_32x32x16_bf16 v[96:111], v[60:63], v[48:51], v[96:111]
v_mfma_f32_32x32x16_bf16 v[112:127], v[60:63], v[52:55], v[112:127]
s_waitcnt lgkmcnt(0)
v_mfma_f32_32x32x16_bf16 v[64:79], v[136:139], v[128:131], v[64:79]
v_mfma_f32_32x32x16_bf16 v[80:95], v[136:139], v[132:135], v[80:95]
v_mfma_f32_32x32x16_bf16 v[96:111], v[140:143], v[128:131], v[96:111]
v_mfma_f32_32x32x16_bf16 v[112:127], v[140:143], v[132:135], v[112:127]
s_waitcnt vmcnt(8)
s_barrier
s_add_u32 s16, s14, 768
s_add_u32 s37, s36, 0
s_mov_b32 m0, s37
s_nop 0
buffer_load_dwordx4 v3, s[8:11], s16 offen lds
s_add_u32 s16, s14, 17152
s_add_u32 s37, s36, 1024
s_mov_b32 m0, s37
s_nop 0
buffer_load_dwordx4 v3, s[8:11], s16 offen lds
s_add_u32 s16, s15, 768
s_add_u32 s37, s36, 8192
s_mov_b32 m0, s37
s_nop 0
buffer_load_dwordx4 v3, s[8:11], s16 offen lds
s_add_u32 s16, s15, 17152
s_add_u32 s37, s36, 9216
s_mov_b32 m0, s37
s_nop 0
buffer_load_dwordx4 v3, s[8:11], s16 offen lds
ds_read_b128 v[48:51], v144 offset:16384
ds_read_b128 v[52:55], v144 offset:18432
ds_read_b128 v[56:59], v146 offset:16384
ds_read_b128 v[60:63], v146 offset:18432
ds_read_b128 v[128:131], v145 offset:16384
ds_read_b128 v[132:135], v145 offset:18432
ds_read_b128 v[136:139], v147 offset:16384
ds_read_b128 v[140:143], v147 offset:18432
s_waitcnt lgkmcnt(4)
v_mfma_f32_32x32x16_bf16 v[64:79], v[56:59], v[48:51], v[64:79]
v_mfma_f32_32x32x16_bf16 v[80:95], v[56:59], v[52:55], v[80:95]
v_mfma_f32_32x32x16_bf16 v[96:111], v[60:63], v[48:51], v[96:111]
v_mfma_f32_32x32x16_bf16 v[112:127], v[60:63], v[52:55], v[112:127]
s_waitcnt lgkmcnt(0)
v_mfma_f32_32x32x16_bf16 v[64:79], v[136:139], v[128:131], v[64:79]
v_mfma_f32_32x32x16_bf16 v[80:95], v[136:139], v[132:135], v[80:95]
v_mfma_f32_32x32x16_bf16 v[96:111], v[140:143], v[128:131], v[96:111]
v_mfma_f32_32x32x16_bf16 v[112:127], v[140:143], v[132:135], v[112:127]
s_waitcnt vmcnt(8)
s_barrier
s_add_u32 s16, s14, 832
s_add_u32 s37, s36, 16384
s_mov_b32 m0, s37
s_nop 0
buffer_load_dwordx4 v3, s[8:11], s16 offen lds
s_add_u32 s16, s14, 17216
s_add_u32 s37, s36, 17408
s_mov_b32 m0, s37
s_nop 0
buffer_load_dwordx4 v3, s[8:11], s16 offen lds
s_add_u32 s16, s15, 832
s_add_u32 s37, s36, 24576
s_mov_b32 m0, s37
s_nop 0
buffer_load_dwordx4 v3, s[8:11], s16 offen lds
s_add_u32 s16, s15, 17216
s_add_u32 s37, s36, 25600
s_mov_b32 m0, s37
s_nop 0
buffer_load_dwordx4 v3, s[8:11], s16 offen lds
ds_read_b128 v[48:51], v144 offset:32768
ds_read_b128 v[52:55], v144 offset:34816
ds_read_b128 v[56:59], v146 offset:32768
ds_read_b128 v[60:63], v146 offset:34816
ds_read_b128 v[128:131], v145 offset:32768
ds_read_b128 v[132:135], v145 offset:34816
ds_read_b128 v[136:139], v147 offset:32768
ds_read_b128 v[140:143], v147 offset:34816
s_waitcnt lgkmcnt(4)
v_mfma_f32_32x32x16_bf16 v[64:79], v[56:59], v[48:51], v[64:79]
v_mfma_f32_32x32x16_bf16 v[80:95], v[56:59], v[52:55], v[80:95]
v_mfma_f32_32x32x16_bf16 v[96:111], v[60:63], v[48:51], v[96:111]
v_mfma_f32_32x32x16_bf16 v[112:127], v[60:63], v[52:55], v[112:127]
s_waitcnt lgkmcnt(0)
v_mfma_f32_32x32x16_bf16 v[64:79], v[136:139], v[128:131], v[64:79]
v_mfma_f32_32x32x16_bf16 v[80:95], v[136:139], v[132:135], v[80:95]
v_mfma_f32_32x32x16_bf16 v[96:111], v[140:143], v[128:131], v[96:111]
v_mfma_f32_32x32x16_bf16 v[112:127], v[140:143], v[132:135], v[112:127]
s_waitcnt vmcnt(8)
s_barrier
s_add_u32 s16, s14, 896
s_add_u32 s37, s36, 32768
s_mov_b32 m0, s37
s_nop 0
buffer_load_dwordx4 v3, s[8:11], s16 offen lds
s_add_u32 s16, s14, 17280
s_add_u32 s37, s36, 33792
s_mov_b32 m0, s37
s_nop 0
buffer_load_dwordx4 v3, s[8:11], s16 offen lds
s_add_u32 s16, s15, 896
s_add_u32 s37, s36, 40960
s_mov_b32 m0, s37
s_nop 0
buffer_load_dwordx4 v3, s[8:11], s16 offen lds
s_add_u32 s16, s15, 17280
s_add_u32 s37, s36, 41984
s_mov_b32 m0, s37
s_nop 0
buffer_load_dwordx4 v3, s[8:11], s16 offen lds
ds_read_b128 v[48:51], v144 offset:49152
ds_read_b128 v[52:55], v144 offset:51200
ds_read_b128 v[56:59], v146 offset:49152
ds_read_b128 v[60:63], v146 offset:51200
ds_read_b128 v[128:131], v145 offset:49152
ds_read_b128 v[132:135], v145 offset:51200
ds_read_b128 v[136:139], v147 offset:49152
ds_read_b128 v[140:143], v147 offset:51200
s_waitcnt lgkmcnt(4)
v_mfma_f32_32x32x16_bf16 v[64:79], v[56:59], v[48:51], v[64:79]
v_mfma_f32_32x32x16_bf16 v[80:95], v[56:59], v[52:55], v[80:95]
v_mfma_f32_32x32x16_bf16 v[96:111], v[60:63], v[48:51], v[96:111]
v_mfma_f32_32x32x16_bf16 v[112:127], v[60:63], v[52:55], v[112:127]
s_waitcnt lgkmcnt(0)
v_mfma_f32_32x32x16_bf16 v[64:79], v[136:139], v[128:131], v[64:79]
v_mfma_f32_32x32x16_bf16 v[80:95], v[136:139], v[132:135], v[80:95]
v_mfma_f32_32x32x16_bf16 v[96:111], v[140:143], v[128:131], v[96:111]
v_mfma_f32_32x32x16_bf16 v[112:127], v[140:143], v[132:135], v[112:127]
s_waitcnt vmcnt(8)
s_barrier
s_add_u32 s16, s14, 960
s_add_u32 s37, s36, 49152
s_mov_b32 m0, s37
s_nop 0
buffer_load_dwordx4 v3, s[8:11], s16 offen lds
s_add_u32 s16, s14, 17344
s_add_u32 s37, s36, 50176
s_mov_b32 m0, s37
s_nop 0
buffer_load_dwordx4 v3, s[8:11], s16 offen lds
s_add_u32 s16, s15, 960
s_add_u32 s37, s36, 57344
s_mov_b32 m0, s37
s_nop 0
buffer_load_dwordx4 v3, s[8:11], s16 offen lds
s_add_u32 s16, s15, 17344
s_add_u32 s37, s36, 58368
s_mov_b32 m0, s37
s_nop 0
buffer_load_dwordx4 v3, s[8:11], s16 offen lds
ds_read_b128 v[48:51], v144 offset:0
ds_read_b128 v[52:55], v144 offset:2048
ds_read_b128 v[56:59], v146 offset:0
ds_read_b128 v[60:63], v146 offset:2048
ds_read_b128 v[128:131], v145 offset:0
ds_read_b128 v[132:135], v145 offset:2048
ds_read_b128 v[136:139], v147 offset:0
ds_read_b128 v[140:143], v147 offset:2048
s_waitcnt lgkmcnt(4)
v_mfma_f32_32x32x16_bf16 v[64:79], v[56:59], v[48:51], v[64:79]
v_mfma_f32_32x32x16_bf16 v[80:95], v[56:59], v[52:55], v[80:95]
v_mfma_f32_32x32x16_bf16 v[96:111], v[60:63], v[48:51], v[96:111]
v_mfma_f32_32x32x16_bf16 v[112:127], v[60:63], v[52:55], v[112:127]
s_waitcnt lgkmcnt(0)
v_mfma_f32_32x32x16_bf16 v[64:79], v[136:139], v[128:131], v[64:79]
v_mfma_f32_32x32x16_bf16 v[80:95], v[136:139], v[132:135], v[80:95]
v_mfma_f32_32x32x16_bf16 v[96:111], v[140:143], v[128:131], v[96:111]
v_mfma_f32_32x32x16_bf16 v[112:127], v[140:143], v[132:135], v[112:127]
s_waitcnt vmcnt(8)
s_barrier
ds_read_b128 v[48:51], v144 offset:16384
ds_read_b128 v[52:55], v144 offset:18432
ds_read_b128 v[56:59], v146 offset:16384
ds_read_b128 v[60:63], v146 offset:18432
ds_read_b128 v[128:131], v145 offset:16384
ds_read_b128 v[132:135], v145 offset:18432
ds_read_b128 v[136:139], v147 offset:16384
ds_read_b128 v[140:143], v147 offset:18432
s_waitcnt lgkmcnt(4)
v_mfma_f32_32x32x16_bf16 v[64:79], v[56:59], v[48:51], v[64:79]
v_mfma_f32_32x32x16_bf16 v[80:95], v[56:59], v[52:55], v[80:95]
v_mfma_f32_32x32x16_bf16 v[96:111], v[60:63], v[48:51], v[96:111]
v_mfma_f32_32x32x16_bf16 v[112:127], v[60:63], v[52:55], v[112:127]
s_waitcnt lgkmcnt(0)
v_mfma_f32_32x32x16_bf16 v[64:79], v[136:139], v[128:131], v[64:79]
v_mfma_f32_32x32x16_bf16 v[80:95], v[136:139], v[132:135], v[80:95]
v_mfma_f32_32x32x16_bf16 v[96:111], v[140:143], v[128:131], v[96:111]
v_mfma_f32_32x32x16_bf16 v[112:127], v[140:143], v[132:135], v[112:127]
s_waitcnt vmcnt(4)
s_barrier
ds_read_b128 v[48:51], v144 offset:32768
ds_read_b128 v[52:55], v144 offset:34816
ds_read_b128 v[56:59], v146 offset:32768
ds_read_b128 v[60:63], v146 offset:34816
ds_read_b128 v[128:131], v145 offset:32768
ds_read_b128 v[132:135], v145 offset:34816
ds_read_b128 v[136:139], v147 offset:32768
ds_read_b128 v[140:143], v147 offset:34816
s_waitcnt lgkmcnt(4)
v_mfma_f32_32x32x16_bf16 v[64:79], v[56:59], v[48:51], v[64:79]
v_mfma_f32_32x32x16_bf16 v[80:95], v[56:59], v[52:55], v[80:95]
v_mfma_f32_32x32x16_bf16 v[96:111], v[60:63], v[48:51], v[96:111]
v_mfma_f32_32x32x16_bf16 v[112:127], v[60:63], v[52:55], v[112:127]
s_waitcnt lgkmcnt(0)
v_mfma_f32_32x32x16_bf16 v[64:79], v[136:139], v[128:131], v[64:79]
v_mfma_f32_32x32x16_bf16 v[80:95], v[136:139], v[132:135], v[80:95]
v_mfma_f32_32x32x16_bf16 v[96:111], v[140:143], v[128:131], v[96:111]
v_mfma_f32_32x32x16_bf16 v[112:127], v[140:143], v[132:135], v[112:127]
s_waitcnt vmcnt(0)
s_barrier
ds_read_b128 v[48:51], v144 offset:49152
ds_read_b128 v[52:55], v144 offset:51200
ds_read_b128 v[56:59], v146 offset:49152
ds_read_b128 v[60:63], v146 offset:51200
ds_read_b128 v[128:131], v145 offset:49152
ds_read_b128 v[132:135], v145 offset:51200
ds_read_b128 v[136:139], v147 offset:49152
ds_read_b128 v[140:143], v147 offset:51200
s_waitcnt lgkmcnt(4)
v_mfma_f32_32x32x16_bf16 v[64:79], v[56:59], v[48:51], v[64:79]
v_mfma_f32_32x32x16_bf16 v[80:95], v[56:59], v[52:55], v[80:95]
v_mfma_f32_32x32x16_bf16 v[96:111], v[60:63], v[48:51], v[96:111]
v_mfma_f32_32x32x16_bf16 v[112:127], v[60:63], v[52:55], v[112:127]
s_waitcnt lgkmcnt(0)
v_mfma_f32_32x32x16_bf16 v[64:79], v[136:139], v[128:131], v[64:79]
v_mfma_f32_32x32x16_bf16 v[80:95], v[136:139], v[132:135], v[80:95]
v_mfma_f32_32x32x16_bf16 v[96:111], v[140:143], v[128:131], v[96:111]
v_mfma_f32_32x32x16_bf16 v[112:127], v[140:143], v[132:135], v[112:127]
s_nop 15
s_nop 7
s_mov_b32 s28, 0x3d372713
s_mov_b32 s29, 3222493025
s_add_u32 s23, s22, 0
v_cvt_pk_bf16_f32 v16, v64, v65
v_cvt_pk_bf16_f32 v17, v66, v67
v_cvt_pk_bf16_f32 v18, v68, v69
v_cvt_pk_bf16_f32 v19, v70, v71
v_lshlrev_b32 v64, 16, v16
v_and_b32 v65, 0xffff0000, v16
v_lshlrev_b32 v20, 16, v32
v_and_b32 v24, 0xffff0000, v32
v_lshlrev_b32 v66, 16, v17
v_and_b32 v67, 0xffff0000, v17
v_lshlrev_b32 v21, 16, v33
v_and_b32 v25, 0xffff0000, v33
v_lshlrev_b32 v68, 16, v18
v_and_b32 v69, 0xffff0000, v18
v_lshlrev_b32 v22, 16, v34
v_and_b32 v26, 0xffff0000, v34
v_lshlrev_b32 v70, 16, v19
v_and_b32 v71, 0xffff0000, v19
v_lshlrev_b32 v23, 16, v35
v_and_b32 v27, 0xffff0000, v35
v_add_f32 v64, v64, v20
v_add_f32 v65, v65, v24
v_add_f32 v66, v66, v21
v_add_f32 v67, v67, v25
v_add_f32 v68, v68, v22
v_add_f32 v69, v69, v26
v_add_f32 v70, v70, v23
v_add_f32 v71, v71, v27
v_cvt_pk_bf16_f32 v16, v64, v65
v_cvt_pk_bf16_f32 v17, v66, v67
v_cvt_pk_bf16_f32 v18, v68, v69
v_cvt_pk_bf16_f32 v19, v70, v71
v_lshlrev_b32 v64, 16, v16
v_and_b32 v65, 0xffff0000, v16
v_lshlrev_b32 v66, 16, v17
v_and_b32 v67, 0xffff0000, v17
v_lshlrev_b32 v68, 16, v18
v_and_b32 v69, 0xffff0000, v18
v_lshlrev_b32 v70, 16, v19
v_and_b32 v71, 0xffff0000, v19
v_mul_f32 v16, v64, v64
v_mul_f32 v17, v65, v65
v_mul_f32 v18, v66, v66
v_mul_f32 v19, v67, v67
v_mul_f32 v20, v68, v68
v_mul_f32 v21, v69, v69
v_mul_f32 v22, v70, v70
v_mul_f32 v23, v71, v71
v_mul_f32 v16, s28, v16
v_mul_f32 v17, s28, v17
v_mul_f32 v18, s28, v18
v_mul_f32 v19, s28, v19
v_mul_f32 v20, s28, v20
v_mul_f32 v21, s28, v21
v_mul_f32 v22, s28, v22
v_mul_f32 v23, s28, v23
v_fma_f32 v16, v16, v64, v64
v_fma_f32 v17, v17, v65, v65
v_fma_f32 v18, v18, v66, v66
v_fma_f32 v19, v19, v67, v67
v_fma_f32 v20, v20, v68, v68
v_fma_f32 v21, v21, v69, v69
v_fma_f32 v22, v22, v70, v70
v_fma_f32 v23, v23, v71, v71
v_mul_f32 v16, s29, v16
v_mul_f32 v17, s29, v17
v_mul_f32 v18, s29, v18
v_mul_f32 v19, s29, v19
v_mul_f32 v20, s29, v20
v_mul_f32 v21, s29, v21
v_mul_f32 v22, s29, v22
v_mul_f32 v23, s29, v23
v_exp_f32 v16, v16
v_exp_f32 v17, v17
v_exp_f32 v18, v18
v_exp_f32 v19, v19
v_exp_f32 v20, v20
v_exp_f32 v21, v21
v_exp_f32 v22, v22
v_exp_f32 v23, v23
v_add_f32 v16, 1.0, v16
v_add_f32 v17, 1.0, v17
v_add_f32 v18, 1.0, v18
v_add_f32 v19, 1.0, v19
v_add_f32 v20, 1.0, v20
v_add_f32 v21, 1.0, v21
v_add_f32 v22, 1.0, v22
v_add_f32 v23, 1.0, v23
v_rcp_f32 v16, v16
v_rcp_f32 v17, v17
v_rcp_f32 v18, v18
v_rcp_f32 v19, v19
v_rcp_f32 v20, v20
v_rcp_f32 v21, v21
v_rcp_f32 v22, v22
v_rcp_f32 v23, v23
v_mul_f32 v64, v64, v16
v_mul_f32 v65, v65, v17
v_mul_f32 v66, v66, v18
v_mul_f32 v67, v67, v19
v_mul_f32 v68, v68, v20
v_mul_f32 v69, v69, v21
v_mul_f32 v70, v70, v22
v_mul_f32 v71, v71, v23
v_cvt_pk_bf16_f32 v48, v64, v65
v_cvt_pk_bf16_f32 v49, v66, v67
v_cvt_pk_bf16_f32 v50, v68, v69
v_cvt_pk_bf16_f32 v51, v70, v71
buffer_store_dwordx2 v[48:49], v13, s[8:11], s23 offen offset:0
buffer_store_dwordx2 v[50:51], v13, s[8:11], s23 offen offset:16
v_cvt_pk_bf16_f32 v16, v72, v73
v_cvt_pk_bf16_f32 v17, v74, v75
v_cvt_pk_bf16_f32 v18, v76, v77
v_cvt_pk_bf16_f32 v19, v78, v79
v_lshlrev_b32 v72, 16, v16
v_and_b32 v73, 0xffff0000, v16
v_lshlrev_b32 v20, 16, v36
v_and_b32 v24, 0xffff0000, v36
v_lshlrev_b32 v74, 16, v17
v_and_b32 v75, 0xffff0000, v17
v_lshlrev_b32 v21, 16, v37
v_and_b32 v25, 0xffff0000, v37
v_lshlrev_b32 v76, 16, v18
v_and_b32 v77, 0xffff0000, v18
v_lshlrev_b32 v22, 16, v38
v_and_b32 v26, 0xffff0000, v38
v_lshlrev_b32 v78, 16, v19
v_and_b32 v79, 0xffff0000, v19
v_lshlrev_b32 v23, 16, v39
v_and_b32 v27, 0xffff0000, v39
v_add_f32 v72, v72, v20
v_add_f32 v73, v73, v24
v_add_f32 v74, v74, v21
v_add_f32 v75, v75, v25
v_add_f32 v76, v76, v22
v_add_f32 v77, v77, v26
v_add_f32 v78, v78, v23
v_add_f32 v79, v79, v27
v_cvt_pk_bf16_f32 v16, v72, v73
v_cvt_pk_bf16_f32 v17, v74, v75
v_cvt_pk_bf16_f32 v18, v76, v77
v_cvt_pk_bf16_f32 v19, v78, v79
v_lshlrev_b32 v72, 16, v16
v_and_b32 v73, 0xffff0000, v16
v_lshlrev_b32 v74, 16, v17
v_and_b32 v75, 0xffff0000, v17
v_lshlrev_b32 v76, 16, v18
v_and_b32 v77, 0xffff0000, v18
v_lshlrev_b32 v78, 16, v19
v_and_b32 v79, 0xffff0000, v19
v_mul_f32 v16, v72, v72
v_mul_f32 v17, v73, v73
v_mul_f32 v18, v74, v74
v_mul_f32 v19, v75, v75
v_mul_f32 v20, v76, v76
v_mul_f32 v21, v77, v77
v_mul_f32 v22, v78, v78
v_mul_f32 v23, v79, v79
v_mul_f32 v16, s28, v16
v_mul_f32 v17, s28, v17
v_mul_f32 v18, s28, v18
v_mul_f32 v19, s28, v19
v_mul_f32 v20, s28, v20
v_mul_f32 v21, s28, v21
v_mul_f32 v22, s28, v22
v_mul_f32 v23, s28, v23
v_fma_f32 v16, v16, v72, v72
v_fma_f32 v17, v17, v73, v73
v_fma_f32 v18, v18, v74, v74
v_fma_f32 v19, v19, v75, v75
v_fma_f32 v20, v20, v76, v76
v_fma_f32 v21, v21, v77, v77
v_fma_f32 v22, v22, v78, v78
v_fma_f32 v23, v23, v79, v79
v_mul_f32 v16, s29, v16
v_mul_f32 v17, s29, v17
v_mul_f32 v18, s29, v18
v_mul_f32 v19, s29, v19
v_mul_f32 v20, s29, v20
v_mul_f32 v21, s29, v21
v_mul_f32 v22, s29, v22
v_mul_f32 v23, s29, v23
v_exp_f32 v16, v16
v_exp_f32 v17, v17
v_exp_f32 v18, v18
v_exp_f32 v19, v19
v_exp_f32 v20, v20
v_exp_f32 v21, v21
v_exp_f32 v22, v22
v_exp_f32 v23, v23
v_add_f32 v16, 1.0, v16
v_add_f32 v17, 1.0, v17
v_add_f32 v18, 1.0, v18
v_add_f32 v19, 1.0, v19
v_add_f32 v20, 1.0, v20
v_add_f32 v21, 1.0, v21
v_add_f32 v22, 1.0, v22
v_add_f32 v23, 1.0, v23
v_rcp_f32 v16, v16
v_rcp_f32 v17, v17
v_rcp_f32 v18, v18
v_rcp_f32 v19, v19
v_rcp_f32 v20, v20
v_rcp_f32 v21, v21
v_rcp_f32 v22, v22
v_rcp_f32 v23, v23
v_mul_f32 v72, v72, v16
v_mul_f32 v73, v73, v17
v_mul_f32 v74, v74, v18
v_mul_f32 v75, v75, v19
v_mul_f32 v76, v76, v20
v_mul_f32 v77, v77, v21
v_mul_f32 v78, v78, v22
v_mul_f32 v79, v79, v23
v_cvt_pk_bf16_f32 v52, v72, v73
v_cvt_pk_bf16_f32 v53, v74, v75
v_cvt_pk_bf16_f32 v54, v76, v77
v_cvt_pk_bf16_f32 v55, v78, v79
buffer_store_dwordx2 v[52:53], v13, s[8:11], s23 offen offset:32
buffer_store_dwordx2 v[54:55], v13, s[8:11], s23 offen offset:48
s_add_u32 s23, s22, 114688
v_cvt_pk_bf16_f32 v16, v80, v81
v_cvt_pk_bf16_f32 v17, v82, v83
v_cvt_pk_bf16_f32 v18, v84, v85
v_cvt_pk_bf16_f32 v19, v86, v87
v_lshlrev_b32 v80, 16, v16
v_and_b32 v81, 0xffff0000, v16
v_lshlrev_b32 v20, 16, v32
v_and_b32 v24, 0xffff0000, v32
v_lshlrev_b32 v82, 16, v17
v_and_b32 v83, 0xffff0000, v17
v_lshlrev_b32 v21, 16, v33
v_and_b32 v25, 0xffff0000, v33
v_lshlrev_b32 v84, 16, v18
v_and_b32 v85, 0xffff0000, v18
v_lshlrev_b32 v22, 16, v34
v_and_b32 v26, 0xffff0000, v34
v_lshlrev_b32 v86, 16, v19
v_and_b32 v87, 0xffff0000, v19
v_lshlrev_b32 v23, 16, v35
v_and_b32 v27, 0xffff0000, v35
v_add_f32 v80, v80, v20
v_add_f32 v81, v81, v24
v_add_f32 v82, v82, v21
v_add_f32 v83, v83, v25
v_add_f32 v84, v84, v22
v_add_f32 v85, v85, v26
v_add_f32 v86, v86, v23
v_add_f32 v87, v87, v27
v_cvt_pk_bf16_f32 v16, v80, v81
v_cvt_pk_bf16_f32 v17, v82, v83
v_cvt_pk_bf16_f32 v18, v84, v85
v_cvt_pk_bf16_f32 v19, v86, v87
v_lshlrev_b32 v80, 16, v16
v_and_b32 v81, 0xffff0000, v16
v_lshlrev_b32 v82, 16, v17
v_and_b32 v83, 0xffff0000, v17
v_lshlrev_b32 v84, 16, v18
v_and_b32 v85, 0xffff0000, v18
v_lshlrev_b32 v86, 16, v19
v_and_b32 v87, 0xffff0000, v19
v_mul_f32 v16, v80, v80
v_mul_f32 v17, v81, v81
v_mul_f32 v18, v82, v82
v_mul_f32 v19, v83, v83
v_mul_f32 v20, v84, v84
v_mul_f32 v21, v85, v85
v_mul_f32 v22, v86, v86
v_mul_f32 v23, v87, v87
v_mul_f32 v16, s28, v16
v_mul_f32 v17, s28, v17
v_mul_f32 v18, s28, v18
v_mul_f32 v19, s28, v19
v_mul_f32 v20, s28, v20
v_mul_f32 v21, s28, v21
v_mul_f32 v22, s28, v22
v_mul_f32 v23, s28, v23
v_fma_f32 v16, v16, v80, v80
v_fma_f32 v17, v17, v81, v81
v_fma_f32 v18, v18, v82, v82
v_fma_f32 v19, v19, v83, v83
v_fma_f32 v20, v20, v84, v84
v_fma_f32 v21, v21, v85, v85
v_fma_f32 v22, v22, v86, v86
v_fma_f32 v23, v23, v87, v87
v_mul_f32 v16, s29, v16
v_mul_f32 v17, s29, v17
v_mul_f32 v18, s29, v18
v_mul_f32 v19, s29, v19
v_mul_f32 v20, s29, v20
v_mul_f32 v21, s29, v21
v_mul_f32 v22, s29, v22
v_mul_f32 v23, s29, v23
v_exp_f32 v16, v16
v_exp_f32 v17, v17
v_exp_f32 v18, v18
v_exp_f32 v19, v19
v_exp_f32 v20, v20
v_exp_f32 v21, v21
v_exp_f32 v22, v22
v_exp_f32 v23, v23
v_add_f32 v16, 1.0, v16
v_add_f32 v17, 1.0, v17
v_add_f32 v18, 1.0, v18
v_add_f32 v19, 1.0, v19
v_add_f32 v20, 1.0, v20
v_add_f32 v21, 1.0, v21
v_add_f32 v22, 1.0, v22
v_add_f32 v23, 1.0, v23
v_rcp_f32 v16, v16
v_rcp_f32 v17, v17
v_rcp_f32 v18, v18
v_rcp_f32 v19, v19
v_rcp_f32 v20, v20
v_rcp_f32 v21, v21
v_rcp_f32 v22, v22
v_rcp_f32 v23, v23
v_mul_f32 v80, v80, v16
v_mul_f32 v81, v81, v17
v_mul_f32 v82, v82, v18
v_mul_f32 v83, v83, v19
v_mul_f32 v84, v84, v20
v_mul_f32 v85, v85, v21
v_mul_f32 v86, v86, v22
v_mul_f32 v87, v87, v23
v_cvt_pk_bf16_f32 v56, v80, v81
v_cvt_pk_bf16_f32 v57, v82, v83
v_cvt_pk_bf16_f32 v58, v84, v85
v_cvt_pk_bf16_f32 v59, v86, v87
buffer_store_dwordx2 v[56:57], v13, s[8:11], s23 offen offset:0
buffer_store_dwordx2 v[58:59], v13, s[8:11], s23 offen offset:16
v_cvt_pk_bf16_f32 v16, v88, v89
v_cvt_pk_bf16_f32 v17, v90, v91
v_cvt_pk_bf16_f32 v18, v92, v93
v_cvt_pk_bf16_f32 v19, v94, v95
v_lshlrev_b32 v88, 16, v16
v_and_b32 v89, 0xffff0000, v16
v_lshlrev_b32 v20, 16, v36
v_and_b32 v24, 0xffff0000, v36
v_lshlrev_b32 v90, 16, v17
v_and_b32 v91, 0xffff0000, v17
v_lshlrev_b32 v21, 16, v37
v_and_b32 v25, 0xffff0000, v37
v_lshlrev_b32 v92, 16, v18
v_and_b32 v93, 0xffff0000, v18
v_lshlrev_b32 v22, 16, v38
v_and_b32 v26, 0xffff0000, v38
v_lshlrev_b32 v94, 16, v19
v_and_b32 v95, 0xffff0000, v19
v_lshlrev_b32 v23, 16, v39
v_and_b32 v27, 0xffff0000, v39
v_add_f32 v88, v88, v20
v_add_f32 v89, v89, v24
v_add_f32 v90, v90, v21
v_add_f32 v91, v91, v25
v_add_f32 v92, v92, v22
v_add_f32 v93, v93, v26
v_add_f32 v94, v94, v23
v_add_f32 v95, v95, v27
v_cvt_pk_bf16_f32 v16, v88, v89
v_cvt_pk_bf16_f32 v17, v90, v91
v_cvt_pk_bf16_f32 v18, v92, v93
v_cvt_pk_bf16_f32 v19, v94, v95
v_lshlrev_b32 v88, 16, v16
v_and_b32 v89, 0xffff0000, v16
v_lshlrev_b32 v90, 16, v17
v_and_b32 v91, 0xffff0000, v17
v_lshlrev_b32 v92, 16, v18
v_and_b32 v93, 0xffff0000, v18
v_lshlrev_b32 v94, 16, v19
v_and_b32 v95, 0xffff0000, v19
v_mul_f32 v16, v88, v88
v_mul_f32 v17, v89, v89
v_mul_f32 v18, v90, v90
v_mul_f32 v19, v91, v91
v_mul_f32 v20, v92, v92
v_mul_f32 v21, v93, v93
v_mul_f32 v22, v94, v94
v_mul_f32 v23, v95, v95
v_mul_f32 v16, s28, v16
v_mul_f32 v17, s28, v17
v_mul_f32 v18, s28, v18
v_mul_f32 v19, s28, v19
v_mul_f32 v20, s28, v20
v_mul_f32 v21, s28, v21
v_mul_f32 v22, s28, v22
v_mul_f32 v23, s28, v23
v_fma_f32 v16, v16, v88, v88
v_fma_f32 v17, v17, v89, v89
v_fma_f32 v18, v18, v90, v90
v_fma_f32 v19, v19, v91, v91
v_fma_f32 v20, v20, v92, v92
v_fma_f32 v21, v21, v93, v93
v_fma_f32 v22, v22, v94, v94
v_fma_f32 v23, v23, v95, v95
v_mul_f32 v16, s29, v16
v_mul_f32 v17, s29, v17
v_mul_f32 v18, s29, v18
v_mul_f32 v19, s29, v19
v_mul_f32 v20, s29, v20
v_mul_f32 v21, s29, v21
v_mul_f32 v22, s29, v22
v_mul_f32 v23, s29, v23
v_exp_f32 v16, v16
v_exp_f32 v17, v17
v_exp_f32 v18, v18
v_exp_f32 v19, v19
v_exp_f32 v20, v20
v_exp_f32 v21, v21
v_exp_f32 v22, v22
v_exp_f32 v23, v23
v_add_f32 v16, 1.0, v16
v_add_f32 v17, 1.0, v17
v_add_f32 v18, 1.0, v18
v_add_f32 v19, 1.0, v19
v_add_f32 v20, 1.0, v20
v_add_f32 v21, 1.0, v21
v_add_f32 v22, 1.0, v22
v_add_f32 v23, 1.0, v23
v_rcp_f32 v16, v16
v_rcp_f32 v17, v17
v_rcp_f32 v18, v18
v_rcp_f32 v19, v19
v_rcp_f32 v20, v20
v_rcp_f32 v21, v21
v_rcp_f32 v22, v22
v_rcp_f32 v23, v23
v_mul_f32 v88, v88, v16
v_mul_f32 v89, v89, v17
v_mul_f32 v90, v90, v18
v_mul_f32 v91, v91, v19
v_mul_f32 v92, v92, v20
v_mul_f32 v93, v93, v21
v_mul_f32 v94, v94, v22
v_mul_f32 v95, v95, v23
v_cvt_pk_bf16_f32 v60, v88, v89
v_cvt_pk_bf16_f32 v61, v90, v91
v_cvt_pk_bf16_f32 v62, v92, v93
v_cvt_pk_bf16_f32 v63, v94, v95
buffer_store_dwordx2 v[60:61], v13, s[8:11], s23 offen offset:32
buffer_store_dwordx2 v[62:63], v13, s[8:11], s23 offen offset:48
s_add_u32 s23, s22, 0
v_cvt_pk_bf16_f32 v16, v96, v97
v_cvt_pk_bf16_f32 v17, v98, v99
v_cvt_pk_bf16_f32 v18, v100, v101
v_cvt_pk_bf16_f32 v19, v102, v103
v_lshlrev_b32 v96, 16, v16
v_and_b32 v97, 0xffff0000, v16
v_lshlrev_b32 v20, 16, v40
v_and_b32 v24, 0xffff0000, v40
v_lshlrev_b32 v98, 16, v17
v_and_b32 v99, 0xffff0000, v17
v_lshlrev_b32 v21, 16, v41
v_and_b32 v25, 0xffff0000, v41
v_lshlrev_b32 v100, 16, v18
v_and_b32 v101, 0xffff0000, v18
v_lshlrev_b32 v22, 16, v42
v_and_b32 v26, 0xffff0000, v42
v_lshlrev_b32 v102, 16, v19
v_and_b32 v103, 0xffff0000, v19
v_lshlrev_b32 v23, 16, v43
v_and_b32 v27, 0xffff0000, v43
v_add_f32 v96, v96, v20
v_add_f32 v97, v97, v24
v_add_f32 v98, v98, v21
v_add_f32 v99, v99, v25
v_add_f32 v100, v100, v22
v_add_f32 v101, v101, v26
v_add_f32 v102, v102, v23
v_add_f32 v103, v103, v27
v_cvt_pk_bf16_f32 v16, v96, v97
v_cvt_pk_bf16_f32 v17, v98, v99
v_cvt_pk_bf16_f32 v18, v100, v101
v_cvt_pk_bf16_f32 v19, v102, v103
v_lshlrev_b32 v96, 16, v16
v_and_b32 v97, 0xffff0000, v16
v_lshlrev_b32 v98, 16, v17
v_and_b32 v99, 0xffff0000, v17
v_lshlrev_b32 v100, 16, v18
v_and_b32 v101, 0xffff0000, v18
v_lshlrev_b32 v102, 16, v19
v_and_b32 v103, 0xffff0000, v19
v_mul_f32 v16, v96, v96
v_mul_f32 v17, v97, v97
v_mul_f32 v18, v98, v98
v_mul_f32 v19, v99, v99
v_mul_f32 v20, v100, v100
v_mul_f32 v21, v101, v101
v_mul_f32 v22, v102, v102
v_mul_f32 v23, v103, v103
v_mul_f32 v16, s28, v16
v_mul_f32 v17, s28, v17
v_mul_f32 v18, s28, v18
v_mul_f32 v19, s28, v19
v_mul_f32 v20, s28, v20
v_mul_f32 v21, s28, v21
v_mul_f32 v22, s28, v22
v_mul_f32 v23, s28, v23
v_fma_f32 v16, v16, v96, v96
v_fma_f32 v17, v17, v97, v97
v_fma_f32 v18, v18, v98, v98
v_fma_f32 v19, v19, v99, v99
v_fma_f32 v20, v20, v100, v100
v_fma_f32 v21, v21, v101, v101
v_fma_f32 v22, v22, v102, v102
v_fma_f32 v23, v23, v103, v103
v_mul_f32 v16, s29, v16
v_mul_f32 v17, s29, v17
v_mul_f32 v18, s29, v18
v_mul_f32 v19, s29, v19
v_mul_f32 v20, s29, v20
v_mul_f32 v21, s29, v21
v_mul_f32 v22, s29, v22
v_mul_f32 v23, s29, v23
v_exp_f32 v16, v16
v_exp_f32 v17, v17
v_exp_f32 v18, v18
v_exp_f32 v19, v19
v_exp_f32 v20, v20
v_exp_f32 v21, v21
v_exp_f32 v22, v22
v_exp_f32 v23, v23
v_add_f32 v16, 1.0, v16
v_add_f32 v17, 1.0, v17
v_add_f32 v18, 1.0, v18
v_add_f32 v19, 1.0, v19
v_add_f32 v20, 1.0, v20
v_add_f32 v21, 1.0, v21
v_add_f32 v22, 1.0, v22
v_add_f32 v23, 1.0, v23
v_rcp_f32 v16, v16
v_rcp_f32 v17, v17
v_rcp_f32 v18, v18
v_rcp_f32 v19, v19
v_rcp_f32 v20, v20
v_rcp_f32 v21, v21
v_rcp_f32 v22, v22
v_rcp_f32 v23, v23
v_mul_f32 v96, v96, v16
v_mul_f32 v97, v97, v17
v_mul_f32 v98, v98, v18
v_mul_f32 v99, v99, v19
v_mul_f32 v100, v100, v20
v_mul_f32 v101, v101, v21
v_mul_f32 v102, v102, v22
v_mul_f32 v103, v103, v23
v_cvt_pk_bf16_f32 v48, v96, v97
v_cvt_pk_bf16_f32 v49, v98, v99
v_cvt_pk_bf16_f32 v50, v100, v101
v_cvt_pk_bf16_f32 v51, v102, v103
buffer_store_dwordx2 v[48:49], v13, s[8:11], s23 offen offset:64
buffer_store_dwordx2 v[50:51], v13, s[8:11], s23 offen offset:80
v_cvt_pk_bf16_f32 v16, v104, v105
v_cvt_pk_bf16_f32 v17, v106, v107
v_cvt_pk_bf16_f32 v18, v108, v109
v_cvt_pk_bf16_f32 v19, v110, v111
v_lshlrev_b32 v104, 16, v16
v_and_b32 v105, 0xffff0000, v16
v_lshlrev_b32 v20, 16, v44
v_and_b32 v24, 0xffff0000, v44
v_lshlrev_b32 v106, 16, v17
v_and_b32 v107, 0xffff0000, v17
v_lshlrev_b32 v21, 16, v45
v_and_b32 v25, 0xffff0000, v45
v_lshlrev_b32 v108, 16, v18
v_and_b32 v109, 0xffff0000, v18
v_lshlrev_b32 v22, 16, v46
v_and_b32 v26, 0xffff0000, v46
v_lshlrev_b32 v110, 16, v19
v_and_b32 v111, 0xffff0000, v19
v_lshlrev_b32 v23, 16, v47
v_and_b32 v27, 0xffff0000, v47
v_add_f32 v104, v104, v20
v_add_f32 v105, v105, v24
v_add_f32 v106, v106, v21
v_add_f32 v107, v107, v25
v_add_f32 v108, v108, v22
v_add_f32 v109, v109, v26
v_add_f32 v110, v110, v23
v_add_f32 v111, v111, v27
v_cvt_pk_bf16_f32 v16, v104, v105
v_cvt_pk_bf16_f32 v17, v106, v107
v_cvt_pk_bf16_f32 v18, v108, v109
v_cvt_pk_bf16_f32 v19, v110, v111
v_lshlrev_b32 v104, 16, v16
v_and_b32 v105, 0xffff0000, v16
v_lshlrev_b32 v106, 16, v17
v_and_b32 v107, 0xffff0000, v17
v_lshlrev_b32 v108, 16, v18
v_and_b32 v109, 0xffff0000, v18
v_lshlrev_b32 v110, 16, v19
v_and_b32 v111, 0xffff0000, v19
v_mul_f32 v16, v104, v104
v_mul_f32 v17, v105, v105
v_mul_f32 v18, v106, v106
v_mul_f32 v19, v107, v107
v_mul_f32 v20, v108, v108
v_mul_f32 v21, v109, v109
v_mul_f32 v22, v110, v110
v_mul_f32 v23, v111, v111
v_mul_f32 v16, s28, v16
v_mul_f32 v17, s28, v17
v_mul_f32 v18, s28, v18
v_mul_f32 v19, s28, v19
v_mul_f32 v20, s28, v20
v_mul_f32 v21, s28, v21
v_mul_f32 v22, s28, v22
v_mul_f32 v23, s28, v23
v_fma_f32 v16, v16, v104, v104
v_fma_f32 v17, v17, v105, v105
v_fma_f32 v18, v18, v106, v106
v_fma_f32 v19, v19, v107, v107
v_fma_f32 v20, v20, v108, v108
v_fma_f32 v21, v21, v109, v109
v_fma_f32 v22, v22, v110, v110
v_fma_f32 v23, v23, v111, v111
v_mul_f32 v16, s29, v16
v_mul_f32 v17, s29, v17
v_mul_f32 v18, s29, v18
v_mul_f32 v19, s29, v19
v_mul_f32 v20, s29, v20
v_mul_f32 v21, s29, v21
v_mul_f32 v22, s29, v22
v_mul_f32 v23, s29, v23
v_exp_f32 v16, v16
v_exp_f32 v17, v17
v_exp_f32 v18, v18
v_exp_f32 v19, v19
v_exp_f32 v20, v20
v_exp_f32 v21, v21
v_exp_f32 v22, v22
v_exp_f32 v23, v23
v_add_f32 v16, 1.0, v16
v_add_f32 v17, 1.0, v17
v_add_f32 v18, 1.0, v18
v_add_f32 v19, 1.0, v19
v_add_f32 v20, 1.0, v20
v_add_f32 v21, 1.0, v21
v_add_f32 v22, 1.0, v22
v_add_f32 v23, 1.0, v23
v_rcp_f32 v16, v16
v_rcp_f32 v17, v17
v_rcp_f32 v18, v18
v_rcp_f32 v19, v19
v_rcp_f32 v20, v20
v_rcp_f32 v21, v21
v_rcp_f32 v22, v22
v_rcp_f32 v23, v23
v_mul_f32 v104, v104, v16
v_mul_f32 v105, v105, v17
v_mul_f32 v106, v106, v18
v_mul_f32 v107, v107, v19
v_mul_f32 v108, v108, v20
v_mul_f32 v109, v109, v21
v_mul_f32 v110, v110, v22
v_mul_f32 v111, v111, v23
v_cvt_pk_bf16_f32 v52, v104, v105
v_cvt_pk_bf16_f32 v53, v106, v107
v_cvt_pk_bf16_f32 v54, v108, v109
v_cvt_pk_bf16_f32 v55, v110, v111
buffer_store_dwordx2 v[52:53], v13, s[8:11], s23 offen offset:96
buffer_store_dwordx2 v[54:55], v13, s[8:11], s23 offen offset:112
s_add_u32 s23, s22, 114688
v_cvt_pk_bf16_f32 v16, v112, v113
v_cvt_pk_bf16_f32 v17, v114, v115
v_cvt_pk_bf16_f32 v18, v116, v117
v_cvt_pk_bf16_f32 v19, v118, v119
v_lshlrev_b32 v112, 16, v16
v_and_b32 v113, 0xffff0000, v16
v_lshlrev_b32 v20, 16, v40
v_and_b32 v24, 0xffff0000, v40
v_lshlrev_b32 v114, 16, v17
v_and_b32 v115, 0xffff0000, v17
v_lshlrev_b32 v21, 16, v41
v_and_b32 v25, 0xffff0000, v41
v_lshlrev_b32 v116, 16, v18
v_and_b32 v117, 0xffff0000, v18
v_lshlrev_b32 v22, 16, v42
v_and_b32 v26, 0xffff0000, v42
v_lshlrev_b32 v118, 16, v19
v_and_b32 v119, 0xffff0000, v19
v_lshlrev_b32 v23, 16, v43
v_and_b32 v27, 0xffff0000, v43
v_add_f32 v112, v112, v20
v_add_f32 v113, v113, v24
v_add_f32 v114, v114, v21
v_add_f32 v115, v115, v25
v_add_f32 v116, v116, v22
v_add_f32 v117, v117, v26
v_add_f32 v118, v118, v23
v_add_f32 v119, v119, v27
v_cvt_pk_bf16_f32 v16, v112, v113
v_cvt_pk_bf16_f32 v17, v114, v115
v_cvt_pk_bf16_f32 v18, v116, v117
v_cvt_pk_bf16_f32 v19, v118, v119
v_lshlrev_b32 v112, 16, v16
v_and_b32 v113, 0xffff0000, v16
v_lshlrev_b32 v114, 16, v17
v_and_b32 v115, 0xffff0000, v17
v_lshlrev_b32 v116, 16, v18
v_and_b32 v117, 0xffff0000, v18
v_lshlrev_b32 v118, 16, v19
v_and_b32 v119, 0xffff0000, v19
v_mul_f32 v16, v112, v112
v_mul_f32 v17, v113, v113
v_mul_f32 v18, v114, v114
v_mul_f32 v19, v115, v115
v_mul_f32 v20, v116, v116
v_mul_f32 v21, v117, v117
v_mul_f32 v22, v118, v118
v_mul_f32 v23, v119, v119
v_mul_f32 v16, s28, v16
v_mul_f32 v17, s28, v17
v_mul_f32 v18, s28, v18
v_mul_f32 v19, s28, v19
v_mul_f32 v20, s28, v20
v_mul_f32 v21, s28, v21
v_mul_f32 v22, s28, v22
v_mul_f32 v23, s28, v23
v_fma_f32 v16, v16, v112, v112
v_fma_f32 v17, v17, v113, v113
v_fma_f32 v18, v18, v114, v114
v_fma_f32 v19, v19, v115, v115
v_fma_f32 v20, v20, v116, v116
v_fma_f32 v21, v21, v117, v117
v_fma_f32 v22, v22, v118, v118
v_fma_f32 v23, v23, v119, v119
v_mul_f32 v16, s29, v16
v_mul_f32 v17, s29, v17
v_mul_f32 v18, s29, v18
v_mul_f32 v19, s29, v19
v_mul_f32 v20, s29, v20
v_mul_f32 v21, s29, v21
v_mul_f32 v22, s29, v22
v_mul_f32 v23, s29, v23
v_exp_f32 v16, v16
v_exp_f32 v17, v17
v_exp_f32 v18, v18
v_exp_f32 v19, v19
v_exp_f32 v20, v20
v_exp_f32 v21, v21
v_exp_f32 v22, v22
v_exp_f32 v23, v23
v_add_f32 v16, 1.0, v16
v_add_f32 v17, 1.0, v17
v_add_f32 v18, 1.0, v18
v_add_f32 v19, 1.0, v19
v_add_f32 v20, 1.0, v20
v_add_f32 v21, 1.0, v21
v_add_f32 v22, 1.0, v22
v_add_f32 v23, 1.0, v23
v_rcp_f32 v16, v16
v_rcp_f32 v17, v17
v_rcp_f32 v18, v18
v_rcp_f32 v19, v19
v_rcp_f32 v20, v20
v_rcp_f32 v21, v21
v_rcp_f32 v22, v22
v_rcp_f32 v23, v23
v_mul_f32 v112, v112, v16
v_mul_f32 v113, v113, v17
v_mul_f32 v114, v114, v18
v_mul_f32 v115, v115, v19
v_mul_f32 v116, v116, v20
v_mul_f32 v117, v117, v21
v_mul_f32 v118, v118, v22
v_mul_f32 v119, v119, v23
v_cvt_pk_bf16_f32 v56, v112, v113
v_cvt_pk_bf16_f32 v57, v114, v115
v_cvt_pk_bf16_f32 v58, v116, v117
v_cvt_pk_bf16_f32 v59, v118, v119
buffer_store_dwordx2 v[56:57], v13, s[8:11], s23 offen offset:64
buffer_store_dwordx2 v[58:59], v13, s[8:11], s23 offen offset:80
v_cvt_pk_bf16_f32 v16, v120, v121
v_cvt_pk_bf16_f32 v17, v122, v123
v_cvt_pk_bf16_f32 v18, v124, v125
v_cvt_pk_bf16_f32 v19, v126, v127
v_lshlrev_b32 v120, 16, v16
v_and_b32 v121, 0xffff0000, v16
v_lshlrev_b32 v20, 16, v44
v_and_b32 v24, 0xffff0000, v44
v_lshlrev_b32 v122, 16, v17
v_and_b32 v123, 0xffff0000, v17
v_lshlrev_b32 v21, 16, v45
v_and_b32 v25, 0xffff0000, v45
v_lshlrev_b32 v124, 16, v18
v_and_b32 v125, 0xffff0000, v18
v_lshlrev_b32 v22, 16, v46
v_and_b32 v26, 0xffff0000, v46
v_lshlrev_b32 v126, 16, v19
v_and_b32 v127, 0xffff0000, v19
v_lshlrev_b32 v23, 16, v47
v_and_b32 v27, 0xffff0000, v47
v_add_f32 v120, v120, v20
v_add_f32 v121, v121, v24
v_add_f32 v122, v122, v21
v_add_f32 v123, v123, v25
v_add_f32 v124, v124, v22
v_add_f32 v125, v125, v26
v_add_f32 v126, v126, v23
v_add_f32 v127, v127, v27
v_cvt_pk_bf16_f32 v16, v120, v121
v_cvt_pk_bf16_f32 v17, v122, v123
v_cvt_pk_bf16_f32 v18, v124, v125
v_cvt_pk_bf16_f32 v19, v126, v127
v_lshlrev_b32 v120, 16, v16
v_and_b32 v121, 0xffff0000, v16
v_lshlrev_b32 v122, 16, v17
v_and_b32 v123, 0xffff0000, v17
v_lshlrev_b32 v124, 16, v18
v_and_b32 v125, 0xffff0000, v18
v_lshlrev_b32 v126, 16, v19
v_and_b32 v127, 0xffff0000, v19
v_mul_f32 v16, v120, v120
v_mul_f32 v17, v121, v121
v_mul_f32 v18, v122, v122
v_mul_f32 v19, v123, v123
v_mul_f32 v20, v124, v124
v_mul_f32 v21, v125, v125
v_mul_f32 v22, v126, v126
v_mul_f32 v23, v127, v127
v_mul_f32 v16, s28, v16
v_mul_f32 v17, s28, v17
v_mul_f32 v18, s28, v18
v_mul_f32 v19, s28, v19
v_mul_f32 v20, s28, v20
v_mul_f32 v21, s28, v21
v_mul_f32 v22, s28, v22
v_mul_f32 v23, s28, v23
v_fma_f32 v16, v16, v120, v120
v_fma_f32 v17, v17, v121, v121
v_fma_f32 v18, v18, v122, v122
v_fma_f32 v19, v19, v123, v123
v_fma_f32 v20, v20, v124, v124
v_fma_f32 v21, v21, v125, v125
v_fma_f32 v22, v22, v126, v126
v_fma_f32 v23, v23, v127, v127
v_mul_f32 v16, s29, v16
v_mul_f32 v17, s29, v17
v_mul_f32 v18, s29, v18
v_mul_f32 v19, s29, v19
v_mul_f32 v20, s29, v20
v_mul_f32 v21, s29, v21
v_mul_f32 v22, s29, v22
v_mul_f32 v23, s29, v23
v_exp_f32 v16, v16
v_exp_f32 v17, v17
v_exp_f32 v18, v18
v_exp_f32 v19, v19
v_exp_f32 v20, v20
v_exp_f32 v21, v21
v_exp_f32 v22, v22
v_exp_f32 v23, v23
v_add_f32 v16, 1.0, v16
v_add_f32 v17, 1.0, v17
v_add_f32 v18, 1.0, v18
v_add_f32 v19, 1.0, v19
v_add_f32 v20, 1.0, v20
v_add_f32 v21, 1.0, v21
v_add_f32 v22, 1.0, v22
v_add_f32 v23, 1.0, v23
v_rcp_f32 v16, v16
v_rcp_f32 v17, v17
v_rcp_f32 v18, v18
v_rcp_f32 v19, v19
v_rcp_f32 v20, v20
v_rcp_f32 v21, v21
v_rcp_f32 v22, v22
v_rcp_f32 v23, v23
v_mul_f32 v120, v120, v16
v_mul_f32 v121, v121, v17
v_mul_f32 v122, v122, v18
v_mul_f32 v123, v123, v19
v_mul_f32 v124, v124, v20
v_mul_f32 v125, v125, v21
v_mul_f32 v126, v126, v22
v_mul_f32 v127, v127, v23
v_cvt_pk_bf16_f32 v60, v120, v121
v_cvt_pk_bf16_f32 v61, v122, v123
v_cvt_pk_bf16_f32 v62, v124, v125
v_cvt_pk_bf16_f32 v63, v126, v127
buffer_store_dwordx2 v[60:61], v13, s[8:11], s23 offen offset:96
buffer_store_dwordx2 v[62:63], v13, s[8:11], s23 offen offset:112
s_branch mid_end
mid_conv:
s_sub_u32 s3, s2, 224
s_load_dwordx2 s[6:7], s[0:1], 64
s_lshl_b32 s12, s3, 5
s_add_u32 s12, s12, 2097152
v_lshlrev_b32 v2, 13, v0
buffer_load_dwordx4 v[12:15], v2, s[8:11], s12 offen
buffer_load_dwordx4 v[16:19], v2, s[8:11], s12 offen offset:16
v_lshrrev_b32 v3, 3, v0
v_add_u32 v3, 31, v3
v_mul_u32_u24 v3, 144, v3
v_and_b32 v4, 7, v0
v_lshl_add_u32 v3, v4, 4, v3
s_mul_i32 s13, s3, 5376
s_add_u32 s13, s13, 8388608
v_add_u32 v5, 0, v0
v_cvt_f32_u32 v6, v5
v_cvt_pk_bf16_f32 v6, v6, v6
v_and_b32 v6, 0xffff, v6
v_subrev_u32 v6, 17024, v6
v_cmp_gt_u32 vcc, 256, v5
s_nop 1
v_cndmask_b32 v6, v6, v5, vcc
v_lshlrev_b32 v6, 2, v6
buffer_load_dword v20, v6, s[8:11], s13 offen
buffer_load_dword v21, v6, s[8:11], s13 offen offset:2688
v_add_u32 v5, 256, v0
v_cvt_f32_u32 v6, v5
v_cvt_pk_bf16_f32 v6, v6, v6
v_and_b32 v6, 0xffff, v6
v_subrev_u32 v6, 17024, v6
v_cmp_gt_u32 vcc, 256, v5
s_nop 1
v_cndmask_b32 v6, v6, v5, vcc
v_lshlrev_b32 v6, 2, v6
buffer_load_dword v22, v6, s[8:11], s13 offen
buffer_load_dword v23, v6, s[8:11], s13 offen offset:2688
v_add_u32 v5, 512, v0
v_cvt_f32_u32 v6, v5
v_cvt_pk_bf16_f32 v6, v6, v6
v_and_b32 v6, 0xffff, v6
v_subrev_u32 v6, 17024, v6
v_cmp_gt_u32 vcc, 256, v5
s_nop 1
v_cndmask_b32 v6, v6, v5, vcc
v_lshlrev_b32 v6, 2, v6
buffer_load_dword v24, v6, s[8:11], s13 offen
buffer_load_dword v25, v6, s[8:11], s13 offen offset:2688
v_add_u32 v5, 768, v0
v_cvt_f32_u32 v6, v5
v_cvt_pk_bf16_f32 v6, v6, v6
v_and_b32 v6, 0xffff, v6
v_subrev_u32 v6, 17024, v6
v_cmp_gt_u32 vcc, 256, v5
s_nop 1
v_cndmask_b32 v6, v6, v5, vcc
v_lshlrev_b32 v6, 2, v6
buffer_load_dword v26, v6, s[8:11], s13 offen
buffer_load_dword v27, v6, s[8:11], s13 offen offset:2688
v_add_u32 v5, 1024, v0
v_cvt_f32_u32 v6, v5
v_cvt_pk_bf16_f32 v6, v6, v6
v_and_b32 v6, 0xffff, v6
v_subrev_u32 v6, 17024, v6
v_cmp_gt_u32 vcc, 256, v5
s_nop 1
v_cndmask_b32 v6, v6, v5, vcc
v_lshlrev_b32 v6, 2, v6
buffer_load_dword v28, v6, s[8:11], s13 offen
buffer_load_dword v29, v6, s[8:11], s13 offen offset:2688
v_add_u32 v5, 1280, v0
v_cvt_f32_u32 v6, v5
v_cvt_pk_bf16_f32 v6, v6, v6
v_and_b32 v6, 0xffff, v6
v_subrev_u32 v6, 17024, v6
v_cmp_gt_u32 vcc, 256, v5
s_nop 1
v_cndmask_b32 v6, v6, v5, vcc
v_lshlrev_b32 v6, 2, v6
buffer_load_dword v30, v6, s[8:11], s13 offen
buffer_load_dword v31, v6, s[8:11], s13 offen offset:2688
v_add_u32 v5, 1536, v0
v_cvt_f32_u32 v6, v5
v_cvt_pk_bf16_f32 v6, v6, v6
v_and_b32 v6, 0xffff, v6
v_subrev_u32 v6, 17024, v6
v_cmp_gt_u32 vcc, 256, v5
s_nop 1
v_cndmask_b32 v6, v6, v5, vcc
v_lshlrev_b32 v6, 2, v6
buffer_load_dword v32, v6, s[8:11], s13 offen
buffer_load_dword v33, v6, s[8:11], s13 offen offset:2688
v_add_u32 v5, 1792, v0
v_cvt_f32_u32 v6, v5
v_cvt_pk_bf16_f32 v6, v6, v6
v_and_b32 v6, 0xffff, v6
v_subrev_u32 v6, 17024, v6
v_cmp_gt_u32 vcc, 256, v5
s_nop 1
v_cndmask_b32 v6, v6, v5, vcc
v_lshlrev_b32 v6, 2, v6
buffer_load_dword v34, v6, s[8:11], s13 offen
buffer_load_dword v35, v6, s[8:11], s13 offen offset:2688
v_mov_b32 v8, 0
v_mov_b32 v9, 0
v_mov_b32 v10, 0
v_mov_b32 v11, 0
v_lshlrev_b32 v1, 4, v0
ds_write_b128 v1, v[8:11] offset:0
v_cmp_gt_u32 vcc, 24, v0
s_and_saveexec_b64 s[20:21], vcc
ds_write_b128 v1, v[8:11] offset:4096
s_mov_b64 exec, s[20:21]
ds_write_b128 v1, v[8:11] offset:9088
v_cmp_gt_u32 vcc, 24, v0
s_and_saveexec_b64 s[20:21], vcc
ds_write_b128 v1, v[8:11] offset:13184
s_mov_b64 exec, s[20:21]
ds_write_b128 v1, v[8:11] offset:18176
ds_write_b128 v1, v[8:11] offset:22272
ds_write_b128 v1, v[8:11] offset:26368
ds_write_b128 v1, v[8:11] offset:30464
ds_write_b128 v1, v[8:11] offset:34560
ds_write_b128 v1, v[8:11] offset:38656
ds_write_b128 v1, v[8:11] offset:42752
ds_write_b128 v1, v[8:11] offset:46848
v_cmp_gt_u32 vcc, 72, v0
s_and_saveexec_b64 s[20:21], vcc
ds_write_b128 v1, v[8:11] offset:50944
s_mov_b64 exec, s[20:21]
s_waitcnt lgkmcnt(0)
s_barrier
s_waitcnt vmcnt(0)
ds_write_b128 v3, v[12:15]
ds_write_b128 v3, v[16:19] offset:9088
s_waitcnt vmcnt(0)
v_lshlrev_b32 v7, 1, v0
v_sub_u32 v7, 4094, v7
v_cvt_pk_bf16_f32 v5, v20, v21
v_subrev_u32 v6, 0, v7
ds_write_b16 v6, v5 offset:18184
ds_write_b16_d16_hi v6, v5 offset:35144
ds_write_b16 v6, v5 offset:22422
ds_write_b16_d16_hi v6, v5 offset:39382
ds_write_b16 v6, v5 offset:26660
ds_write_b16_d16_hi v6, v5 offset:43620
ds_write_b16 v6, v5 offset:30898
ds_write_b16_d16_hi v6, v5 offset:47858
v_cvt_pk_bf16_f32 v5, v22, v23
v_subrev_u32 v6, 512, v7
ds_write_b16 v6, v5 offset:18184
ds_write_b16_d16_hi v6, v5 offset:35144
ds_write_b16 v6, v5 offset:22422
ds_write_b16_d16_hi v6, v5 offset:39382
ds_write_b16 v6, v5 offset:26660
ds_write_b16_d16_hi v6, v5 offset:43620
ds_write_b16 v6, v5 offset:30898
ds_write_b16_d16_hi v6, v5 offset:47858
v_cvt_pk_bf16_f32 v5, v24, v25
v_subrev_u32 v6, 1024, v7
ds_write_b16 v6, v5 offset:18184
ds_write_b16_d16_hi v6, v5 offset:35144
ds_write_b16 v6, v5 offset:22422
ds_write_b16_d16_hi v6, v5 offset:39382
ds_write_b16 v6, v5 offset:26660
ds_write_b16_d16_hi v6, v5 offset:43620
ds_write_b16 v6, v5 offset:30898
ds_write_b16_d16_hi v6, v5 offset:47858
v_cvt_pk_bf16_f32 v5, v26, v27
v_subrev_u32 v6, 1536, v7
ds_write_b16 v6, v5 offset:18184
ds_write_b16_d16_hi v6, v5 offset:35144
ds_write_b16 v6, v5 offset:22422
ds_write_b16_d16_hi v6, v5 offset:39382
ds_write_b16 v6, v5 offset:26660
ds_write_b16_d16_hi v6, v5 offset:43620
ds_write_b16 v6, v5 offset:30898
ds_write_b16_d16_hi v6, v5 offset:47858
v_cvt_pk_bf16_f32 v5, v28, v29
v_subrev_u32 v6, 2048, v7
ds_write_b16 v6, v5 offset:18184
ds_write_b16_d16_hi v6, v5 offset:35144
ds_write_b16 v6, v5 offset:22422
ds_write_b16_d16_hi v6, v5 offset:39382
ds_write_b16 v6, v5 offset:26660
ds_write_b16_d16_hi v6, v5 offset:43620
ds_write_b16 v6, v5 offset:30898
ds_write_b16_d16_hi v6, v5 offset:47858
v_cvt_pk_bf16_f32 v5, v30, v31
v_subrev_u32 v6, 2560, v7
ds_write_b16 v6, v5 offset:18184
ds_write_b16_d16_hi v6, v5 offset:35144
ds_write_b16 v6, v5 offset:22422
ds_write_b16_d16_hi v6, v5 offset:39382
ds_write_b16 v6, v5 offset:26660
ds_write_b16_d16_hi v6, v5 offset:43620
ds_write_b16 v6, v5 offset:30898
ds_write_b16_d16_hi v6, v5 offset:47858
v_cvt_pk_bf16_f32 v5, v32, v33
v_subrev_u32 v6, 3072, v7
ds_write_b16 v6, v5 offset:18184
ds_write_b16_d16_hi v6, v5 offset:35144
ds_write_b16 v6, v5 offset:22422
ds_write_b16_d16_hi v6, v5 offset:39382
ds_write_b16 v6, v5 offset:26660
ds_write_b16_d16_hi v6, v5 offset:43620
ds_write_b16 v6, v5 offset:30898
ds_write_b16_d16_hi v6, v5 offset:47858
v_cvt_pk_bf16_f32 v5, v34, v35
v_subrev_u32 v6, 3584, v7
ds_write_b16 v6, v5 offset:18184
ds_write_b16_d16_hi v6, v5 offset:35144
ds_write_b16 v6, v5 offset:22422
ds_write_b16_d16_hi v6, v5 offset:39382
ds_write_b16 v6, v5 offset:26660
ds_write_b16_d16_hi v6, v5 offset:43620
ds_write_b16 v6, v5 offset:30898
ds_write_b16_d16_hi v6, v5 offset:47858
s_waitcnt lgkmcnt(0)
s_barrier
v_lshrrev_b32 v5, 6, v0
v_lshrrev_b32 v8, 1, v5
v_and_b32 v9, 1, v5
v_and_b32 v6, 31, v0
v_bfe_u32 v7, v0, 5, 1
v_lshlrev_b32 v10, 5, v9
v_add_u32 v10, v10, v6
v_sub_u32 v10, 63, v10
v_lshl_add_u32 v10, v7, 3, v10
v_and_b32 v13, 3, v10
v_and_b32 v10, -4, v10
v_lshlrev_b32 v10, 1, v10
v_mul_u32_u24 v13, 4240, v13
v_add3_u32 v10, v10, v13, 8
v_mul_u32_u24 v12, 16960, v8
v_add_u32 v10, v10, v12
v_add_u32 v10, 18176, v10
v_mul_u32_u24 v11, 144, v6
v_lshl_add_u32 v11, v7, 4, v11
v_mul_u32_u24 v12, 9088, v8
v_add_u32 v11, v11, v12
v_mov_b32 v64, 0
v_mov_b32 v65, 0
v_mov_b32 v66, 0
v_mov_b32 v67, 0
v_mov_b32 v68, 0
v_mov_b32 v69, 0
v_mov_b32 v70, 0
v_mov_b32 v71, 0
v_mov_b32 v72, 0
v_mov_b32 v73, 0
v_mov_b32 v74, 0
v_mov_b32 v75, 0
v_mov_b32 v76, 0
v_mov_b32 v77, 0
v_mov_b32 v78, 0
v_mov_b32 v79, 0
ds_read_b64 v[16:17], v10 offset:3968
ds_read_b64 v[18:19], v10 offset:3976
ds_read_b128 v[20:23], v11 offset:4464
ds_read_b64 v[24:25], v10 offset:4000
ds_read_b64 v[26:27], v10 offset:4008
ds_read_b128 v[28:31], v11 offset:4496
ds_read_b64 v[32:33], v10 offset:4032
ds_read_b64 v[34:35], v10 offset:4040
ds_read_b128 v[36:39], v11 offset:4528
ds_read_b64 v[40:41], v10 offset:4064
ds_read_b64 v[42:43], v10 offset:4072
ds_read_b128 v[44:47], v11 offset:4560
s_waitcnt lgkmcnt(9)
v_mfma_f32_32x32x16_bf16 v[64:79], v[16:19], v[20:23], v[64:79]
ds_read_b64 v[16:17], v10 offset:3840
ds_read_b64 v[18:19], v10 offset:3848
ds_read_b128 v[20:23], v11 offset:4320
s_waitcnt lgkmcnt(9)
v_mfma_f32_32x32x16_bf16 v[64:79], v[24:27], v[28:31], v[64:79]
ds_read_b64 v[24:25], v10 offset:3872
ds_read_b64 v[26:27], v10 offset:3880
ds_read_b128 v[28:31], v11 offset:4352
s_waitcnt lgkmcnt(9)
v_mfma_f32_32x32x16_bf16 v[64:79], v[32:35], v[36:39], v[64:79]
ds_read_b64 v[32:33], v10 offset:3904
ds_read_b64 v[34:35], v10 offset:3912
ds_read_b128 v[36:39], v11 offset:4384
s_waitcnt lgkmcnt(9)
v_mfma_f32_32x32x16_bf16 v[64:79], v[40:43], v[44:47], v[64:79]
ds_read_b64 v[40:41], v10 offset:3936
ds_read_b64 v[42:43], v10 offset:3944
ds_read_b128 v[44:47], v11 offset:4416
s_waitcnt lgkmcnt(9)
v_mfma_f32_32x32x16_bf16 v[64:79], v[16:19], v[20:23], v[64:79]
ds_read_b64 v[16:17], v10 offset:3712
ds_read_b64 v[18:19], v10 offset:3720
ds_read_b128 v[20:23], v11 offset:4176
s_waitcnt lgkmcnt(9)
v_mfma_f32_32x32x16_bf16 v[64:79], v[24:27], v[28:31], v[64:79]
ds_read_b64 v[24:25], v10 offset:3744
ds_read_b64 v[26:27], v10 offset:3752
ds_read_b128 v[28:31], v11 offset:4208
s_waitcnt lgkmcnt(9)
v_mfma_f32_32x32x16_bf16 v[64:79], v[32:35], v[36:39], v[64:79]
ds_read_b64 v[32:33], v10 offset:3776
ds_read_b64 v[34:35], v10 offset:3784
ds_read_b128 v[36:39], v11 offset:4240
s_waitcnt lgkmcnt(9)
v_mfma_f32_32x32x16_bf16 v[64:79], v[40:43], v[44:47], v[64:79]
ds_read_b64 v[40:41], v10 offset:3808
ds_read_b64 v[42:43], v10 offset:3816
ds_read_b128 v[44:47], v11 offset:4272
s_waitcnt lgkmcnt(9)
v_mfma_f32_32x32x16_bf16 v[64:79], v[16:19], v[20:23], v[64:79]
ds_read_b64 v[16:17], v10 offset:3584
ds_read_b64 v[18:19], v10 offset:3592
ds_read_b128 v[20:23], v11 offset:4032
s_waitcnt lgkmcnt(9)
v_mfma_f32_32x32x16_bf16 v[64:79], v[24:27], v[28:31], v[64:79]
ds_read_b64 v[24:25], v10 offset:3616
ds_read_b64 v[26:27], v10 offset:3624
ds_read_b128 v[28:31], v11 offset:4064
s_waitcnt lgkmcnt(9)
v_mfma_f32_32x32x16_bf16 v[64:79], v[32:35], v[36:39], v[64:79]
ds_read_b64 v[32:33], v10 offset:3648
ds_read_b64 v[34:35], v10 offset:3656
ds_read_b128 v[36:39], v11 offset:4096
s_waitcnt lgkmcnt(9)
v_mfma_f32_32x32x16_bf16 v[64:79], v[40:43], v[44:47], v[64:79]
ds_read_b64 v[40:41], v10 offset:3680
ds_read_b64 v[42:43], v10 offset:3688
ds_read_b128 v[44:47], v11 offset:4128
s_waitcnt lgkmcnt(9)
v_mfma_f32_32x32x16_bf16 v[64:79], v[16:19], v[20:23], v[64:79]
ds_read_b64 v[16:17], v10 offset:3456
ds_read_b64 v[18:19], v10 offset:3464
ds_read_b128 v[20:23], v11 offset:3888
s_waitcnt lgkmcnt(9)
v_mfma_f32_32x32x16_bf16 v[64:79], v[24:27], v[28:31], v[64:79]
ds_read_b64 v[24:25], v10 offset:3488
ds_read_b64 v[26:27], v10 offset:3496
ds_read_b128 v[28:31], v11 offset:3920
s_waitcnt lgkmcnt(9)
v_mfma_f32_32x32x16_bf16 v[64:79], v[32:35], v[36:39], v[64:79]
ds_read_b64 v[32:33], v10 offset:3520
ds_read_b64 v[34:35], v10 offset:3528
ds_read_b128 v[36:39], v11 offset:3952
s_waitcnt lgkmcnt(9)
v_mfma_f32_32x32x16_bf16 v[64:79], v[40:43], v[44:47], v[64:79]
ds_read_b64 v[40:41], v10 offset:3552
ds_read_b64 v[42:43], v10 offset:3560
ds_read_b128 v[44:47], v11 offset:3984
s_waitcnt lgkmcnt(9)
v_mfma_f32_32x32x16_bf16 v[64:79], v[16:19], v[20:23], v[64:79]
ds_read_b64 v[16:17], v10 offset:3328
ds_read_b64 v[18:19], v10 offset:3336
ds_read_b128 v[20:23], v11 offset:3744
s_waitcnt lgkmcnt(9)
v_mfma_f32_32x32x16_bf16 v[64:79], v[24:27], v[28:31], v[64:79]
ds_read_b64 v[24:25], v10 offset:3360
ds_read_b64 v[26:27], v10 offset:3368
ds_read_b128 v[28:31], v11 offset:3776
s_waitcnt lgkmcnt(9)
v_mfma_f32_32x32x16_bf16 v[64:79], v[32:35], v[36:39], v[64:79]
ds_read_b64 v[32:33], v10 offset:3392
ds_read_b64 v[34:35], v10 offset:3400
ds_read_b128 v[36:39], v11 offset:3808
s_waitcnt lgkmcnt(9)
v_mfma_f32_32x32x16_bf16 v[64:79], v[40:43], v[44:47], v[64:79]
ds_read_b64 v[40:41], v10 offset:3424
ds_read_b64 v[42:43], v10 offset:3432
ds_read_b128 v[44:47], v11 offset:3840
s_waitcnt lgkmcnt(9)
v_mfma_f32_32x32x16_bf16 v[64:79], v[16:19], v[20:23], v[64:79]
ds_read_b64 v[16:17], v10 offset:3200
ds_read_b64 v[18:19], v10 offset:3208
ds_read_b128 v[20:23], v11 offset:3600
s_waitcnt lgkmcnt(9)
v_mfma_f32_32x32x16_bf16 v[64:79], v[24:27], v[28:31], v[64:79]
ds_read_b64 v[24:25], v10 offset:3232
ds_read_b64 v[26:27], v10 offset:3240
ds_read_b128 v[28:31], v11 offset:3632
s_waitcnt lgkmcnt(9)
v_mfma_f32_32x32x16_bf16 v[64:79], v[32:35], v[36:39], v[64:79]
ds_read_b64 v[32:33], v10 offset:3264
ds_read_b64 v[34:35], v10 offset:3272
ds_read_b128 v[36:39], v11 offset:3664
s_waitcnt lgkmcnt(9)
v_mfma_f32_32x32x16_bf16 v[64:79], v[40:43], v[44:47], v[64:79]
ds_read_b64 v[40:41], v10 offset:3296
ds_read_b64 v[42:43], v10 offset:3304
ds_read_b128 v[44:47], v11 offset:3696
s_waitcnt lgkmcnt(9)
v_mfma_f32_32x32x16_bf16 v[64:79], v[16:19], v[20:23], v[64:79]
ds_read_b64 v[16:17], v10 offset:3072
ds_read_b64 v[18:19], v10 offset:3080
ds_read_b128 v[20:23], v11 offset:3456
s_waitcnt lgkmcnt(9)
v_mfma_f32_32x32x16_bf16 v[64:79], v[24:27], v[28:31], v[64:79]
ds_read_b64 v[24:25], v10 offset:3104
ds_read_b64 v[26:27], v10 offset:3112
ds_read_b128 v[28:31], v11 offset:3488
s_waitcnt lgkmcnt(9)
v_mfma_f32_32x32x16_bf16 v[64:79], v[32:35], v[36:39], v[64:79]
ds_read_b64 v[32:33], v10 offset:3136
ds_read_b64 v[34:35], v10 offset:3144
ds_read_b128 v[36:39], v11 offset:3520
s_waitcnt lgkmcnt(9)
v_mfma_f32_32x32x16_bf16 v[64:79], v[40:43], v[44:47], v[64:79]
ds_read_b64 v[40:41], v10 offset:3168
ds_read_b64 v[42:43], v10 offset:3176
ds_read_b128 v[44:47], v11 offset:3552
s_waitcnt lgkmcnt(9)
v_mfma_f32_32x32x16_bf16 v[64:79], v[16:19], v[20:23], v[64:79]
ds_read_b64 v[16:17], v10 offset:2944
ds_read_b64 v[18:19], v10 offset:2952
ds_read_b128 v[20:23], v11 offset:3312
s_waitcnt lgkmcnt(9)
v_mfma_f32_32x32x16_bf16 v[64:79], v[24:27], v[28:31], v[64:79]
ds_read_b64 v[24:25], v10 offset:2976
ds_read_b64 v[26:27], v10 offset:2984
ds_read_b128 v[28:31], v11 offset:3344
s_waitcnt lgkmcnt(9)
v_mfma_f32_32x32x16_bf16 v[64:79], v[32:35], v[36:39], v[64:79]
ds_read_b64 v[32:33], v10 offset:3008
ds_read_b64 v[34:35], v10 offset:3016
ds_read_b128 v[36:39], v11 offset:3376
s_waitcnt lgkmcnt(9)
v_mfma_f32_32x32x16_bf16 v[64:79], v[40:43], v[44:47], v[64:79]
ds_read_b64 v[40:41], v10 offset:3040
ds_read_b64 v[42:43], v10 offset:3048
ds_read_b128 v[44:47], v11 offset:3408
s_waitcnt lgkmcnt(9)
v_mfma_f32_32x32x16_bf16 v[64:79], v[16:19], v[20:23], v[64:79]
ds_read_b64 v[16:17], v10 offset:2816
ds_read_b64 v[18:19], v10 offset:2824
ds_read_b128 v[20:23], v11 offset:3168
s_waitcnt lgkmcnt(9)
v_mfma_f32_32x32x16_bf16 v[64:79], v[24:27], v[28:31], v[64:79]
ds_read_b64 v[24:25], v10 offset:2848
ds_read_b64 v[26:27], v10 offset:2856
ds_read_b128 v[28:31], v11 offset:3200
s_waitcnt lgkmcnt(9)
v_mfma_f32_32x32x16_bf16 v[64:79], v[32:35], v[36:39], v[64:79]
ds_read_b64 v[32:33], v10 offset:2880
ds_read_b64 v[34:35], v10 offset:2888
ds_read_b128 v[36:39], v11 offset:3232
s_waitcnt lgkmcnt(9)
v_mfma_f32_32x32x16_bf16 v[64:79], v[40:43], v[44:47], v[64:79]
ds_read_b64 v[40:41], v10 offset:2912
ds_read_b64 v[42:43], v10 offset:2920
ds_read_b128 v[44:47], v11 offset:3264
s_waitcnt lgkmcnt(9)
v_mfma_f32_32x32x16_bf16 v[64:79], v[16:19], v[20:23], v[64:79]
ds_read_b64 v[16:17], v10 offset:2688
ds_read_b64 v[18:19], v10 offset:2696
ds_read_b128 v[20:23], v11 offset:3024
s_waitcnt lgkmcnt(9)
v_mfma_f32_32x32x16_bf16 v[64:79], v[24:27], v[28:31], v[64:79]
ds_read_b64 v[24:25], v10 offset:2720
ds_read_b64 v[26:27], v10 offset:2728
ds_read_b128 v[28:31], v11 offset:3056
s_waitcnt lgkmcnt(9)
v_mfma_f32_32x32x16_bf16 v[64:79], v[32:35], v[36:39], v[64:79]
ds_read_b64 v[32:33], v10 offset:2752
ds_read_b64 v[34:35], v10 offset:2760
ds_read_b128 v[36:39], v11 offset:3088
s_waitcnt lgkmcnt(9)
v_mfma_f32_32x32x16_bf16 v[64:79], v[40:43], v[44:47], v[64:79]
ds_read_b64 v[40:41], v10 offset:2784
ds_read_b64 v[42:43], v10 offset:2792
ds_read_b128 v[44:47], v11 offset:3120
s_waitcnt lgkmcnt(9)
v_mfma_f32_32x32x16_bf16 v[64:79], v[16:19], v[20:23], v[64:79]
ds_read_b64 v[16:17], v10 offset:2560
ds_read_b64 v[18:19], v10 offset:2568
ds_read_b128 v[20:23], v11 offset:2880
s_waitcnt lgkmcnt(9)
v_mfma_f32_32x32x16_bf16 v[64:79], v[24:27], v[28:31], v[64:79]
ds_read_b64 v[24:25], v10 offset:2592
ds_read_b64 v[26:27], v10 offset:2600
ds_read_b128 v[28:31], v11 offset:2912
s_waitcnt lgkmcnt(9)
v_mfma_f32_32x32x16_bf16 v[64:79], v[32:35], v[36:39], v[64:79]
ds_read_b64 v[32:33], v10 offset:2624
ds_read_b64 v[34:35], v10 offset:2632
ds_read_b128 v[36:39], v11 offset:2944
s_waitcnt lgkmcnt(9)
v_mfma_f32_32x32x16_bf16 v[64:79], v[40:43], v[44:47], v[64:79]
ds_read_b64 v[40:41], v10 offset:2656
ds_read_b64 v[42:43], v10 offset:2664
ds_read_b128 v[44:47], v11 offset:2976
s_waitcnt lgkmcnt(9)
v_mfma_f32_32x32x16_bf16 v[64:79], v[16:19], v[20:23], v[64:79]
ds_read_b64 v[16:17], v10 offset:2432
ds_read_b64 v[18:19], v10 offset:2440
ds_read_b128 v[20:23], v11 offset:2736
s_waitcnt lgkmcnt(9)
v_mfma_f32_32x32x16_bf16 v[64:79], v[24:27], v[28:31], v[64:79]
ds_read_b64 v[24:25], v10 offset:2464
ds_read_b64 v[26:27], v10 offset:2472
ds_read_b128 v[28:31], v11 offset:2768
s_waitcnt lgkmcnt(9)
v_mfma_f32_32x32x16_bf16 v[64:79], v[32:35], v[36:39], v[64:79]
ds_read_b64 v[32:33], v10 offset:2496
ds_read_b64 v[34:35], v10 offset:2504
ds_read_b128 v[36:39], v11 offset:2800
s_waitcnt lgkmcnt(9)
v_mfma_f32_32x32x16_bf16 v[64:79], v[40:43], v[44:47], v[64:79]
ds_read_b64 v[40:41], v10 offset:2528
ds_read_b64 v[42:43], v10 offset:2536
ds_read_b128 v[44:47], v11 offset:2832
s_waitcnt lgkmcnt(9)
v_mfma_f32_32x32x16_bf16 v[64:79], v[16:19], v[20:23], v[64:79]
ds_read_b64 v[16:17], v10 offset:2304
ds_read_b64 v[18:19], v10 offset:2312
ds_read_b128 v[20:23], v11 offset:2592
s_waitcnt lgkmcnt(9)
v_mfma_f32_32x32x16_bf16 v[64:79], v[24:27], v[28:31], v[64:79]
ds_read_b64 v[24:25], v10 offset:2336
ds_read_b64 v[26:27], v10 offset:2344
ds_read_b128 v[28:31], v11 offset:2624
s_waitcnt lgkmcnt(9)
v_mfma_f32_32x32x16_bf16 v[64:79], v[32:35], v[36:39], v[64:79]
ds_read_b64 v[32:33], v10 offset:2368
ds_read_b64 v[34:35], v10 offset:2376
ds_read_b128 v[36:39], v11 offset:2656
s_waitcnt lgkmcnt(9)
v_mfma_f32_32x32x16_bf16 v[64:79], v[40:43], v[44:47], v[64:79]
ds_read_b64 v[40:41], v10 offset:2400
ds_read_b64 v[42:43], v10 offset:2408
ds_read_b128 v[44:47], v11 offset:2688
s_waitcnt lgkmcnt(9)
v_mfma_f32_32x32x16_bf16 v[64:79], v[16:19], v[20:23], v[64:79]
ds_read_b64 v[16:17], v10 offset:2176
ds_read_b64 v[18:19], v10 offset:2184
ds_read_b128 v[20:23], v11 offset:2448
s_waitcnt lgkmcnt(9)
v_mfma_f32_32x32x16_bf16 v[64:79], v[24:27], v[28:31], v[64:79]
ds_read_b64 v[24:25], v10 offset:2208
ds_read_b64 v[26:27], v10 offset:2216
ds_read_b128 v[28:31], v11 offset:2480
s_waitcnt lgkmcnt(9)
v_mfma_f32_32x32x16_bf16 v[64:79], v[32:35], v[36:39], v[64:79]
ds_read_b64 v[32:33], v10 offset:2240
ds_read_b64 v[34:35], v10 offset:2248
ds_read_b128 v[36:39], v11 offset:2512
s_waitcnt lgkmcnt(9)
v_mfma_f32_32x32x16_bf16 v[64:79], v[40:43], v[44:47], v[64:79]
ds_read_b64 v[40:41], v10 offset:2272
ds_read_b64 v[42:43], v10 offset:2280
ds_read_b128 v[44:47], v11 offset:2544
s_waitcnt lgkmcnt(9)
v_mfma_f32_32x32x16_bf16 v[64:79], v[16:19], v[20:23], v[64:79]
ds_read_b64 v[16:17], v10 offset:2048
ds_read_b64 v[18:19], v10 offset:2056
ds_read_b128 v[20:23], v11 offset:2304
s_waitcnt lgkmcnt(9)
v_mfma_f32_32x32x16_bf16 v[64:79], v[24:27], v[28:31], v[64:79]
ds_read_b64 v[24:25], v10 offset:2080
ds_read_b64 v[26:27], v10 offset:2088
ds_read_b128 v[28:31], v11 offset:2336
s_waitcnt lgkmcnt(9)
v_mfma_f32_32x32x16_bf16 v[64:79], v[32:35], v[36:39], v[64:79]
ds_read_b64 v[32:33], v10 offset:2112
ds_read_b64 v[34:35], v10 offset:2120
ds_read_b128 v[36:39], v11 offset:2368
s_waitcnt lgkmcnt(9)
v_mfma_f32_32x32x16_bf16 v[64:79], v[40:43], v[44:47], v[64:79]
ds_read_b64 v[40:41], v10 offset:2144
ds_read_b64 v[42:43], v10 offset:2152
ds_read_b128 v[44:47], v11 offset:2400
s_waitcnt lgkmcnt(9)
v_mfma_f32_32x32x16_bf16 v[64:79], v[16:19], v[20:23], v[64:79]
ds_read_b64 v[16:17], v10 offset:1920
ds_read_b64 v[18:19], v10 offset:1928
ds_read_b128 v[20:23], v11 offset:2160
s_waitcnt lgkmcnt(9)
v_mfma_f32_32x32x16_bf16 v[64:79], v[24:27], v[28:31], v[64:79]
ds_read_b64 v[24:25], v10 offset:1952
ds_read_b64 v[26:27], v10 offset:1960
ds_read_b128 v[28:31], v11 offset:2192
s_waitcnt lgkmcnt(9)
v_mfma_f32_32x32x16_bf16 v[64:79], v[32:35], v[36:39], v[64:79]
ds_read_b64 v[32:33], v10 offset:1984
ds_read_b64 v[34:35], v10 offset:1992
ds_read_b128 v[36:39], v11 offset:2224
s_waitcnt lgkmcnt(9)
v_mfma_f32_32x32x16_bf16 v[64:79], v[40:43], v[44:47], v[64:79]
ds_read_b64 v[40:41], v10 offset:2016
ds_read_b64 v[42:43], v10 offset:2024
ds_read_b128 v[44:47], v11 offset:2256
s_waitcnt lgkmcnt(9)
v_mfma_f32_32x32x16_bf16 v[64:79], v[16:19], v[20:23], v[64:79]
ds_read_b64 v[16:17], v10 offset:1792
ds_read_b64 v[18:19], v10 offset:1800
ds_read_b128 v[20:23], v11 offset:2016
s_waitcnt lgkmcnt(9)
v_mfma_f32_32x32x16_bf16 v[64:79], v[24:27], v[28:31], v[64:79]
ds_read_b64 v[24:25], v10 offset:1824
ds_read_b64 v[26:27], v10 offset:1832
ds_read_b128 v[28:31], v11 offset:2048
s_waitcnt lgkmcnt(9)
v_mfma_f32_32x32x16_bf16 v[64:79], v[32:35], v[36:39], v[64:79]
ds_read_b64 v[32:33], v10 offset:1856
ds_read_b64 v[34:35], v10 offset:1864
ds_read_b128 v[36:39], v11 offset:2080
s_waitcnt lgkmcnt(9)
v_mfma_f32_32x32x16_bf16 v[64:79], v[40:43], v[44:47], v[64:79]
ds_read_b64 v[40:41], v10 offset:1888
ds_read_b64 v[42:43], v10 offset:1896
ds_read_b128 v[44:47], v11 offset:2112
s_waitcnt lgkmcnt(9)
v_mfma_f32_32x32x16_bf16 v[64:79], v[16:19], v[20:23], v[64:79]
ds_read_b64 v[16:17], v10 offset:1664
ds_read_b64 v[18:19], v10 offset:1672
ds_read_b128 v[20:23], v11 offset:1872
s_waitcnt lgkmcnt(9)
v_mfma_f32_32x32x16_bf16 v[64:79], v[24:27], v[28:31], v[64:79]
ds_read_b64 v[24:25], v10 offset:1696
ds_read_b64 v[26:27], v10 offset:1704
ds_read_b128 v[28:31], v11 offset:1904
s_waitcnt lgkmcnt(9)
v_mfma_f32_32x32x16_bf16 v[64:79], v[32:35], v[36:39], v[64:79]
ds_read_b64 v[32:33], v10 offset:1728
ds_read_b64 v[34:35], v10 offset:1736
ds_read_b128 v[36:39], v11 offset:1936
s_waitcnt lgkmcnt(9)
v_mfma_f32_32x32x16_bf16 v[64:79], v[40:43], v[44:47], v[64:79]
ds_read_b64 v[40:41], v10 offset:1760
ds_read_b64 v[42:43], v10 offset:1768
ds_read_b128 v[44:47], v11 offset:1968
s_waitcnt lgkmcnt(9)
v_mfma_f32_32x32x16_bf16 v[64:79], v[16:19], v[20:23], v[64:79]
ds_read_b64 v[16:17], v10 offset:1536
ds_read_b64 v[18:19], v10 offset:1544
ds_read_b128 v[20:23], v11 offset:1728
s_waitcnt lgkmcnt(9)
v_mfma_f32_32x32x16_bf16 v[64:79], v[24:27], v[28:31], v[64:79]
ds_read_b64 v[24:25], v10 offset:1568
ds_read_b64 v[26:27], v10 offset:1576
ds_read_b128 v[28:31], v11 offset:1760
s_waitcnt lgkmcnt(9)
v_mfma_f32_32x32x16_bf16 v[64:79], v[32:35], v[36:39], v[64:79]
ds_read_b64 v[32:33], v10 offset:1600
ds_read_b64 v[34:35], v10 offset:1608
ds_read_b128 v[36:39], v11 offset:1792
s_waitcnt lgkmcnt(9)
v_mfma_f32_32x32x16_bf16 v[64:79], v[40:43], v[44:47], v[64:79]
ds_read_b64 v[40:41], v10 offset:1632
ds_read_b64 v[42:43], v10 offset:1640
ds_read_b128 v[44:47], v11 offset:1824
s_waitcnt lgkmcnt(9)
v_mfma_f32_32x32x16_bf16 v[64:79], v[16:19], v[20:23], v[64:79]
ds_read_b64 v[16:17], v10 offset:1408
ds_read_b64 v[18:19], v10 offset:1416
ds_read_b128 v[20:23], v11 offset:1584
s_waitcnt lgkmcnt(9)
v_mfma_f32_32x32x16_bf16 v[64:79], v[24:27], v[28:31], v[64:79]
ds_read_b64 v[24:25], v10 offset:1440
ds_read_b64 v[26:27], v10 offset:1448
ds_read_b128 v[28:31], v11 offset:1616
s_waitcnt lgkmcnt(9)
v_mfma_f32_32x32x16_bf16 v[64:79], v[32:35], v[36:39], v[64:79]
ds_read_b64 v[32:33], v10 offset:1472
ds_read_b64 v[34:35], v10 offset:1480
ds_read_b128 v[36:39], v11 offset:1648
s_waitcnt lgkmcnt(9)
v_mfma_f32_32x32x16_bf16 v[64:79], v[40:43], v[44:47], v[64:79]
ds_read_b64 v[40:41], v10 offset:1504
ds_read_b64 v[42:43], v10 offset:1512
ds_read_b128 v[44:47], v11 offset:1680
s_waitcnt lgkmcnt(9)
v_mfma_f32_32x32x16_bf16 v[64:79], v[16:19], v[20:23], v[64:79]
ds_read_b64 v[16:17], v10 offset:1280
ds_read_b64 v[18:19], v10 offset:1288
ds_read_b128 v[20:23], v11 offset:1440
s_waitcnt lgkmcnt(9)
v_mfma_f32_32x32x16_bf16 v[64:79], v[24:27], v[28:31], v[64:79]
ds_read_b64 v[24:25], v10 offset:1312
ds_read_b64 v[26:27], v10 offset:1320
ds_read_b128 v[28:31], v11 offset:1472
s_waitcnt lgkmcnt(9)
v_mfma_f32_32x32x16_bf16 v[64:79], v[32:35], v[36:39], v[64:79]
ds_read_b64 v[32:33], v10 offset:1344
ds_read_b64 v[34:35], v10 offset:1352
ds_read_b128 v[36:39], v11 offset:1504
s_waitcnt lgkmcnt(9)
v_mfma_f32_32x32x16_bf16 v[64:79], v[40:43], v[44:47], v[64:79]
ds_read_b64 v[40:41], v10 offset:1376
ds_read_b64 v[42:43], v10 offset:1384
ds_read_b128 v[44:47], v11 offset:1536
s_waitcnt lgkmcnt(9)
v_mfma_f32_32x32x16_bf16 v[64:79], v[16:19], v[20:23], v[64:79]
ds_read_b64 v[16:17], v10 offset:1152
ds_read_b64 v[18:19], v10 offset:1160
ds_read_b128 v[20:23], v11 offset:1296
s_waitcnt lgkmcnt(9)
v_mfma_f32_32x32x16_bf16 v[64:79], v[24:27], v[28:31], v[64:79]
ds_read_b64 v[24:25], v10 offset:1184
ds_read_b64 v[26:27], v10 offset:1192
ds_read_b128 v[28:31], v11 offset:1328
s_waitcnt lgkmcnt(9)
v_mfma_f32_32x32x16_bf16 v[64:79], v[32:35], v[36:39], v[64:79]
ds_read_b64 v[32:33], v10 offset:1216
ds_read_b64 v[34:35], v10 offset:1224
ds_read_b128 v[36:39], v11 offset:1360
s_waitcnt lgkmcnt(9)
v_mfma_f32_32x32x16_bf16 v[64:79], v[40:43], v[44:47], v[64:79]
ds_read_b64 v[40:41], v10 offset:1248
ds_read_b64 v[42:43], v10 offset:1256
ds_read_b128 v[44:47], v11 offset:1392
s_waitcnt lgkmcnt(9)
v_mfma_f32_32x32x16_bf16 v[64:79], v[16:19], v[20:23], v[64:79]
ds_read_b64 v[16:17], v10 offset:1024
ds_read_b64 v[18:19], v10 offset:1032
ds_read_b128 v[20:23], v11 offset:1152
s_waitcnt lgkmcnt(9)
v_mfma_f32_32x32x16_bf16 v[64:79], v[24:27], v[28:31], v[64:79]
ds_read_b64 v[24:25], v10 offset:1056
ds_read_b64 v[26:27], v10 offset:1064
ds_read_b128 v[28:31], v11 offset:1184
s_waitcnt lgkmcnt(9)
v_mfma_f32_32x32x16_bf16 v[64:79], v[32:35], v[36:39], v[64:79]
ds_read_b64 v[32:33], v10 offset:1088
ds_read_b64 v[34:35], v10 offset:1096
ds_read_b128 v[36:39], v11 offset:1216
s_waitcnt lgkmcnt(9)
v_mfma_f32_32x32x16_bf16 v[64:79], v[40:43], v[44:47], v[64:79]
ds_read_b64 v[40:41], v10 offset:1120
ds_read_b64 v[42:43], v10 offset:1128
ds_read_b128 v[44:47], v11 offset:1248
s_waitcnt lgkmcnt(9)
v_mfma_f32_32x32x16_bf16 v[64:79], v[16:19], v[20:23], v[64:79]
ds_read_b64 v[16:17], v10 offset:896
ds_read_b64 v[18:19], v10 offset:904
ds_read_b128 v[20:23], v11 offset:1008
s_waitcnt lgkmcnt(9)
v_mfma_f32_32x32x16_bf16 v[64:79], v[24:27], v[28:31], v[64:79]
ds_read_b64 v[24:25], v10 offset:928
ds_read_b64 v[26:27], v10 offset:936
ds_read_b128 v[28:31], v11 offset:1040
s_waitcnt lgkmcnt(9)
v_mfma_f32_32x32x16_bf16 v[64:79], v[32:35], v[36:39], v[64:79]
ds_read_b64 v[32:33], v10 offset:960
ds_read_b64 v[34:35], v10 offset:968
ds_read_b128 v[36:39], v11 offset:1072
s_waitcnt lgkmcnt(9)
v_mfma_f32_32x32x16_bf16 v[64:79], v[40:43], v[44:47], v[64:79]
ds_read_b64 v[40:41], v10 offset:992
ds_read_b64 v[42:43], v10 offset:1000
ds_read_b128 v[44:47], v11 offset:1104
s_waitcnt lgkmcnt(9)
v_mfma_f32_32x32x16_bf16 v[64:79], v[16:19], v[20:23], v[64:79]
ds_read_b64 v[16:17], v10 offset:768
ds_read_b64 v[18:19], v10 offset:776
ds_read_b128 v[20:23], v11 offset:864
s_waitcnt lgkmcnt(9)
v_mfma_f32_32x32x16_bf16 v[64:79], v[24:27], v[28:31], v[64:79]
ds_read_b64 v[24:25], v10 offset:800
ds_read_b64 v[26:27], v10 offset:808
ds_read_b128 v[28:31], v11 offset:896
s_waitcnt lgkmcnt(9)
v_mfma_f32_32x32x16_bf16 v[64:79], v[32:35], v[36:39], v[64:79]
ds_read_b64 v[32:33], v10 offset:832
ds_read_b64 v[34:35], v10 offset:840
ds_read_b128 v[36:39], v11 offset:928
s_waitcnt lgkmcnt(9)
v_mfma_f32_32x32x16_bf16 v[64:79], v[40:43], v[44:47], v[64:79]
ds_read_b64 v[40:41], v10 offset:864
ds_read_b64 v[42:43], v10 offset:872
ds_read_b128 v[44:47], v11 offset:960
s_waitcnt lgkmcnt(9)
v_mfma_f32_32x32x16_bf16 v[64:79], v[16:19], v[20:23], v[64:79]
ds_read_b64 v[16:17], v10 offset:640
ds_read_b64 v[18:19], v10 offset:648
ds_read_b128 v[20:23], v11 offset:720
s_waitcnt lgkmcnt(9)
v_mfma_f32_32x32x16_bf16 v[64:79], v[24:27], v[28:31], v[64:79]
ds_read_b64 v[24:25], v10 offset:672
ds_read_b64 v[26:27], v10 offset:680
ds_read_b128 v[28:31], v11 offset:752
s_waitcnt lgkmcnt(9)
v_mfma_f32_32x32x16_bf16 v[64:79], v[32:35], v[36:39], v[64:79]
ds_read_b64 v[32:33], v10 offset:704
ds_read_b64 v[34:35], v10 offset:712
ds_read_b128 v[36:39], v11 offset:784
s_waitcnt lgkmcnt(9)
v_mfma_f32_32x32x16_bf16 v[64:79], v[40:43], v[44:47], v[64:79]
ds_read_b64 v[40:41], v10 offset:736
ds_read_b64 v[42:43], v10 offset:744
ds_read_b128 v[44:47], v11 offset:816
s_waitcnt lgkmcnt(9)
v_mfma_f32_32x32x16_bf16 v[64:79], v[16:19], v[20:23], v[64:79]
ds_read_b64 v[16:17], v10 offset:512
ds_read_b64 v[18:19], v10 offset:520
ds_read_b128 v[20:23], v11 offset:576
s_waitcnt lgkmcnt(9)
v_mfma_f32_32x32x16_bf16 v[64:79], v[24:27], v[28:31], v[64:79]
ds_read_b64 v[24:25], v10 offset:544
ds_read_b64 v[26:27], v10 offset:552
ds_read_b128 v[28:31], v11 offset:608
s_waitcnt lgkmcnt(9)
v_mfma_f32_32x32x16_bf16 v[64:79], v[32:35], v[36:39], v[64:79]
ds_read_b64 v[32:33], v10 offset:576
ds_read_b64 v[34:35], v10 offset:584
ds_read_b128 v[36:39], v11 offset:640
s_waitcnt lgkmcnt(9)
v_mfma_f32_32x32x16_bf16 v[64:79], v[40:43], v[44:47], v[64:79]
ds_read_b64 v[40:41], v10 offset:608
ds_read_b64 v[42:43], v10 offset:616
ds_read_b128 v[44:47], v11 offset:672
s_waitcnt lgkmcnt(9)
v_mfma_f32_32x32x16_bf16 v[64:79], v[16:19], v[20:23], v[64:79]
ds_read_b64 v[16:17], v10 offset:384
ds_read_b64 v[18:19], v10 offset:392
ds_read_b128 v[20:23], v11 offset:432
s_waitcnt lgkmcnt(9)
v_mfma_f32_32x32x16_bf16 v[64:79], v[24:27], v[28:31], v[64:79]
ds_read_b64 v[24:25], v10 offset:416
ds_read_b64 v[26:27], v10 offset:424
ds_read_b128 v[28:31], v11 offset:464
s_waitcnt lgkmcnt(9)
v_mfma_f32_32x32x16_bf16 v[64:79], v[32:35], v[36:39], v[64:79]
ds_read_b64 v[32:33], v10 offset:448
ds_read_b64 v[34:35], v10 offset:456
ds_read_b128 v[36:39], v11 offset:496
s_waitcnt lgkmcnt(9)
v_mfma_f32_32x32x16_bf16 v[64:79], v[40:43], v[44:47], v[64:79]
ds_read_b64 v[40:41], v10 offset:480
ds_read_b64 v[42:43], v10 offset:488
ds_read_b128 v[44:47], v11 offset:528
s_waitcnt lgkmcnt(9)
v_mfma_f32_32x32x16_bf16 v[64:79], v[16:19], v[20:23], v[64:79]
ds_read_b64 v[16:17], v10 offset:256
ds_read_b64 v[18:19], v10 offset:264
ds_read_b128 v[20:23], v11 offset:288
s_waitcnt lgkmcnt(9)
v_mfma_f32_32x32x16_bf16 v[64:79], v[24:27], v[28:31], v[64:79]
ds_read_b64 v[24:25], v10 offset:288
ds_read_b64 v[26:27], v10 offset:296
ds_read_b128 v[28:31], v11 offset:320
s_waitcnt lgkmcnt(9)
v_mfma_f32_32x32x16_bf16 v[64:79], v[32:35], v[36:39], v[64:79]
ds_read_b64 v[32:33], v10 offset:320
ds_read_b64 v[34:35], v10 offset:328
ds_read_b128 v[36:39], v11 offset:352
s_waitcnt lgkmcnt(9)
v_mfma_f32_32x32x16_bf16 v[64:79], v[40:43], v[44:47], v[64:79]
ds_read_b64 v[40:41], v10 offset:352
ds_read_b64 v[42:43], v10 offset:360
ds_read_b128 v[44:47], v11 offset:384
s_waitcnt lgkmcnt(9)
v_mfma_f32_32x32x16_bf16 v[64:79], v[16:19], v[20:23], v[64:79]
ds_read_b64 v[16:17], v10 offset:128
ds_read_b64 v[18:19], v10 offset:136
ds_read_b128 v[20:23], v11 offset:144
s_waitcnt lgkmcnt(9)
v_mfma_f32_32x32x16_bf16 v[64:79], v[24:27], v[28:31], v[64:79]
ds_read_b64 v[24:25], v10 offset:160
ds_read_b64 v[26:27], v10 offset:168
ds_read_b128 v[28:31], v11 offset:176
s_waitcnt lgkmcnt(9)
v_mfma_f32_32x32x16_bf16 v[64:79], v[32:35], v[36:39], v[64:79]
ds_read_b64 v[32:33], v10 offset:192
ds_read_b64 v[34:35], v10 offset:200
ds_read_b128 v[36:39], v11 offset:208
s_waitcnt lgkmcnt(9)
v_mfma_f32_32x32x16_bf16 v[64:79], v[40:43], v[44:47], v[64:79]
ds_read_b64 v[40:41], v10 offset:224
ds_read_b64 v[42:43], v10 offset:232
ds_read_b128 v[44:47], v11 offset:240
s_waitcnt lgkmcnt(9)
v_mfma_f32_32x32x16_bf16 v[64:79], v[16:19], v[20:23], v[64:79]
ds_read_b64 v[16:17], v10 offset:0
ds_read_b64 v[18:19], v10 offset:8
ds_read_b128 v[20:23], v11 offset:0
s_waitcnt lgkmcnt(9)
v_mfma_f32_32x32x16_bf16 v[64:79], v[24:27], v[28:31], v[64:79]
ds_read_b64 v[24:25], v10 offset:32
ds_read_b64 v[26:27], v10 offset:40
ds_read_b128 v[28:31], v11 offset:32
s_waitcnt lgkmcnt(9)
v_mfma_f32_32x32x16_bf16 v[64:79], v[32:35], v[36:39], v[64:79]
ds_read_b64 v[32:33], v10 offset:64
ds_read_b64 v[34:35], v10 offset:72
ds_read_b128 v[36:39], v11 offset:64
s_waitcnt lgkmcnt(9)
v_mfma_f32_32x32x16_bf16 v[64:79], v[40:43], v[44:47], v[64:79]
ds_read_b64 v[40:41], v10 offset:96
ds_read_b64 v[42:43], v10 offset:104
ds_read_b128 v[44:47], v11 offset:96
s_waitcnt lgkmcnt(9)
v_mfma_f32_32x32x16_bf16 v[64:79], v[16:19], v[20:23], v[64:79]
s_waitcnt lgkmcnt(6)
v_mfma_f32_32x32x16_bf16 v[64:79], v[24:27], v[28:31], v[64:79]
s_waitcnt lgkmcnt(3)
v_mfma_f32_32x32x16_bf16 v[64:79], v[32:35], v[36:39], v[64:79]
s_waitcnt lgkmcnt(0)
v_mfma_f32_32x32x16_bf16 v[64:79], v[40:43], v[44:47], v[64:79]
s_nop 15
s_nop 7
s_waitcnt lgkmcnt(0)
s_mov_b32 s16, s6
s_and_b32 s17, s7, 0xffff
s_mov_b32 s18, 1024
s_mov_b32 s19, 0x00020000
s_lshl_b32 s20, s3, 2
v_lshlrev_b32 v13, 1, v8
v_add_u32 v13, s20, v13
buffer_load_ushort v13, v13, s[16:19], 0 offen
v_mul_u32_u24 v14, 144, v6
v_add_u32 v14, v14, v12
v_lshl_add_u32 v14, v9, 6, v14
v_lshl_add_u32 v14, v7, 3, v14
v_lshlrev_b32 v15, 7, v6
v_lshl_add_u32 v15, v9, 6, v15
v_lshl_add_u32 v15, v7, 3, v15
v_lshl_add_u32 v15, v8, 12, v15
s_lshl_b32 s21, s3, 13
s_add_u32 s21, s21, 18874368
s_waitcnt vmcnt(0)
v_lshlrev_b32 v13, 16, v13
ds_read_b64 v[16:17], v14 offset:4464
s_waitcnt lgkmcnt(0)
v_lshlrev_b32 v20, 16, v16
v_and_b32 v21, 0xffff0000, v16
v_lshlrev_b32 v22, 16, v17
v_and_b32 v23, 0xffff0000, v17
v_mul_f32 v20, v20, v13
v_mov_b32 v24, v64
v_mul_f32 v21, v21, v13
v_mov_b32 v25, v65
v_mul_f32 v22, v22, v13
v_mov_b32 v26, v66
v_mul_f32 v23, v23, v13
v_mov_b32 v27, v67
v_cvt_pk_bf16_f32 v30, v20, v21
v_lshlrev_b32 v20, 16, v30
v_and_b32 v21, 0xffff0000, v30
v_cvt_pk_bf16_f32 v30, v22, v23
v_lshlrev_b32 v22, 16, v30
v_and_b32 v23, 0xffff0000, v30
v_cvt_pk_bf16_f32 v30, v24, v25
v_lshlrev_b32 v24, 16, v30
v_and_b32 v25, 0xffff0000, v30
v_cvt_pk_bf16_f32 v30, v26, v27
v_lshlrev_b32 v26, 16, v30
v_and_b32 v27, 0xffff0000, v30
v_add_f32 v24, v24, v20
v_add_f32 v25, v25, v21
v_add_f32 v26, v26, v22
v_add_f32 v27, v27, v23
v_cvt_pk_bf16_f32 v32, v24, v25
v_cvt_pk_bf16_f32 v33, v26, v27
buffer_store_dwordx2 v[32:33], v15, s[8:11], s21 offen offset:0
ds_read_b64 v[16:17], v14 offset:4480
s_waitcnt lgkmcnt(0)
v_lshlrev_b32 v20, 16, v16
v_and_b32 v21, 0xffff0000, v16
v_lshlrev_b32 v22, 16, v17
v_and_b32 v23, 0xffff0000, v17
v_mul_f32 v20, v20, v13
v_mov_b32 v24, v68
v_mul_f32 v21, v21, v13
v_mov_b32 v25, v69
v_mul_f32 v22, v22, v13
v_mov_b32 v26, v70
v_mul_f32 v23, v23, v13
v_mov_b32 v27, v71
v_cvt_pk_bf16_f32 v30, v20, v21
v_lshlrev_b32 v20, 16, v30
v_and_b32 v21, 0xffff0000, v30
v_cvt_pk_bf16_f32 v30, v22, v23
v_lshlrev_b32 v22, 16, v30
v_and_b32 v23, 0xffff0000, v30
v_cvt_pk_bf16_f32 v30, v24, v25
v_lshlrev_b32 v24, 16, v30
v_and_b32 v25, 0xffff0000, v30
v_cvt_pk_bf16_f32 v30, v26, v27
v_lshlrev_b32 v26, 16, v30
v_and_b32 v27, 0xffff0000, v30
v_add_f32 v24, v24, v20
v_add_f32 v25, v25, v21
v_add_f32 v26, v26, v22
v_add_f32 v27, v27, v23
v_cvt_pk_bf16_f32 v32, v24, v25
v_cvt_pk_bf16_f32 v33, v26, v27
buffer_store_dwordx2 v[32:33], v15, s[8:11], s21 offen offset:16
ds_read_b64 v[16:17], v14 offset:4496
s_waitcnt lgkmcnt(0)
v_lshlrev_b32 v20, 16, v16
v_and_b32 v21, 0xffff0000, v16
v_lshlrev_b32 v22, 16, v17
v_and_b32 v23, 0xffff0000, v17
v_mul_f32 v20, v20, v13
v_mov_b32 v24, v72
v_mul_f32 v21, v21, v13
v_mov_b32 v25, v73
v_mul_f32 v22, v22, v13
v_mov_b32 v26, v74
v_mul_f32 v23, v23, v13
v_mov_b32 v27, v75
v_cvt_pk_bf16_f32 v30, v20, v21
v_lshlrev_b32 v20, 16, v30
v_and_b32 v21, 0xffff0000, v30
v_cvt_pk_bf16_f32 v30, v22, v23
v_lshlrev_b32 v22, 16, v30
v_and_b32 v23, 0xffff0000, v30
v_cvt_pk_bf16_f32 v30, v24, v25
v_lshlrev_b32 v24, 16, v30
v_and_b32 v25, 0xffff0000, v30
v_cvt_pk_bf16_f32 v30, v26, v27
v_lshlrev_b32 v26, 16, v30
v_and_b32 v27, 0xffff0000, v30
v_add_f32 v24, v24, v20
v_add_f32 v25, v25, v21
v_add_f32 v26, v26, v22
v_add_f32 v27, v27, v23
v_cvt_pk_bf16_f32 v32, v24, v25
v_cvt_pk_bf16_f32 v33, v26, v27
buffer_store_dwordx2 v[32:33], v15, s[8:11], s21 offen offset:32
ds_read_b64 v[16:17], v14 offset:4512
s_waitcnt lgkmcnt(0)
v_lshlrev_b32 v20, 16, v16
v_and_b32 v21, 0xffff0000, v16
v_lshlrev_b32 v22, 16, v17
v_and_b32 v23, 0xffff0000, v17
v_mul_f32 v20, v20, v13
v_mov_b32 v24, v76
v_mul_f32 v21, v21, v13
v_mov_b32 v25, v77
v_mul_f32 v22, v22, v13
v_mov_b32 v26, v78
v_mul_f32 v23, v23, v13
v_mov_b32 v27, v79
v_cvt_pk_bf16_f32 v30, v20, v21
v_lshlrev_b32 v20, 16, v30
v_and_b32 v21, 0xffff0000, v30
v_cvt_pk_bf16_f32 v30, v22, v23
v_lshlrev_b32 v22, 16, v30
v_and_b32 v23, 0xffff0000, v30
v_cvt_pk_bf16_f32 v30, v24, v25
v_lshlrev_b32 v24, 16, v30
v_and_b32 v25, 0xffff0000, v30
v_cvt_pk_bf16_f32 v30, v26, v27
v_lshlrev_b32 v26, 16, v30
v_and_b32 v27, 0xffff0000, v30
v_add_f32 v24, v24, v20
v_add_f32 v25, v25, v21
v_add_f32 v26, v26, v22
v_add_f32 v27, v27, v23
v_cvt_pk_bf16_f32 v32, v24, v25
v_cvt_pk_bf16_f32 v33, v26, v27
buffer_store_dwordx2 v[32:33], v15, s[8:11], s21 offen offset:48
mid_end:
s_endpgm
.p2align 8
fin_kernel:
s_cmp_ge_u32 s2, 256
s_cbranch_scc1 fin_end
s_load_dwordx2 s[4:5], s[0:1], 128
s_waitcnt lgkmcnt(0)
s_mov_b32 s8, s4
s_and_b32 s9, s5, 0xffff
s_mov_b32 s10, 33554432
s_mov_b32 s11, 0x00020000
s_and_b32 s12, s2, 7
s_lshl_b32 s12, s12, 2
s_lshr_b32 s13, s2, 6
s_add_u32 s12, s12, s13
s_bfe_u32 s13, s2, 0x30003
s_mul_i32 s14, s12, 229376
s_add_u32 s14, s14, 10485760
s_mul_i32 s15, s13, 229376
s_add_u32 s15, s15, 6291456
v_lshrrev_b32 v5, 6, v0
v_and_b32 v6, 31, v0
v_bfe_u32 v7, v0, 5, 1
v_lshrrev_b32 v8, 1, v5
v_and_b32 v9, 1, v5
v_bfe_u32 v1, v0, 4, 2
v_and_b32 v2, 15, v0
s_mov_b32 s21, 3584
v_add_u32 v3, 0, v1
v_xor_b32 v4, v2, v3
v_lshl_add_u32 v3, v5, 4, v3
v_mul_lo_u32 v3, v3, s21
v_lshl_add_u32 v112, v4, 4, v3
v_add_u32 v3, 4, v1
v_xor_b32 v4, v2, v3
v_lshl_add_u32 v3, v5, 4, v3
v_mul_lo_u32 v3, v3, s21
v_lshl_add_u32 v113, v4, 4, v3
v_add_u32 v3, 8, v1
v_xor_b32 v4, v2, v3
v_lshl_add_u32 v3, v5, 4, v3
v_mul_lo_u32 v3, v3, s21
v_lshl_add_u32 v114, v4, 4, v3
v_add_u32 v3, 12, v1
v_xor_b32 v4, v2, v3
v_lshl_add_u32 v3, v5, 4, v3
v_mul_lo_u32 v3, v3, s21
v_lshl_add_u32 v115, v4, 4, v3
v_readfirstlane_b32 s36, v5
s_nop 3
s_lshl_b32 s36, s36, 12
v_lshl_add_u32 v10, v8, 5, v6
v_and_b32 v11, 15, v10
v_xor_b32 v11, v11, v7
v_lshlrev_b32 v10, 8, v10
v_lshl_add_u32 v12, v9, 5, v6
v_and_b32 v13, 15, v12
v_xor_b32 v13, v13, v7
v_lshlrev_b32 v12, 8, v12
v_add_u32 v12, 16384, v12
v_xor_b32 v1, 0, v11
v_lshl_add_u32 v116, v1, 4, v10
v_add_u32 v132, 0x10000, v116
v_xor_b32 v1, 0, v13
v_lshl_add_u32 v124, v1, 4, v12
v_add_u32 v140, 0x10000, v124
v_xor_b32 v1, 2, v11
v_lshl_add_u32 v117, v1, 4, v10
v_add_u32 v133, 0x10000, v117
v_xor_b32 v1, 2, v13
v_lshl_add_u32 v125, v1, 4, v12
v_add_u32 v141, 0x10000, v125
v_xor_b32 v1, 4, v11
v_lshl_add_u32 v118, v1, 4, v10
v_add_u32 v134, 0x10000, v118
v_xor_b32 v1, 4, v13
v_lshl_add_u32 v126, v1, 4, v12
v_add_u32 v142, 0x10000, v126
v_xor_b32 v1, 6, v11
v_lshl_add_u32 v119, v1, 4, v10
v_add_u32 v135, 0x10000, v119
v_xor_b32 v1, 6, v13
v_lshl_add_u32 v127, v1, 4, v12
v_add_u32 v143, 0x10000, v127
v_xor_b32 v1, 8, v11
v_lshl_add_u32 v120, v1, 4, v10
v_add_u32 v136, 0x10000, v120
v_xor_b32 v1, 8, v13
v_lshl_add_u32 v128, v1, 4, v12
v_add_u32 v144, 0x10000, v128
v_xor_b32 v1, 10, v11
v_lshl_add_u32 v121, v1, 4, v10
v_add_u32 v137, 0x10000, v121
v_xor_b32 v1, 10, v13
v_lshl_add_u32 v129, v1, 4, v12
v_add_u32 v145, 0x10000, v129
v_xor_b32 v1, 12, v11
v_lshl_add_u32 v122, v1, 4, v10
v_add_u32 v138, 0x10000, v122
v_xor_b32 v1, 12, v13
v_lshl_add_u32 v130, v1, 4, v12
v_add_u32 v146, 0x10000, v130
v_xor_b32 v1, 14, v11
v_lshl_add_u32 v123, v1, 4, v10
v_add_u32 v139, 0x10000, v123
v_xor_b32 v1, 14, v13
v_lshl_add_u32 v131, v1, 4, v12
v_add_u32 v147, 0x10000, v131
v_mov_b32 v64, 0
v_mov_b32 v65, 0
v_mov_b32 v66, 0
v_mov_b32 v67, 0
v_mov_b32 v68, 0
v_mov_b32 v69, 0
v_mov_b32 v70, 0
v_mov_b32 v71, 0
v_mov_b32 v72, 0
v_mov_b32 v73, 0
v_mov_b32 v74, 0
v_mov_b32 v75, 0
v_mov_b32 v76, 0
v_mov_b32 v77, 0
v_mov_b32 v78, 0
v_mov_b32 v79, 0
s_load_dwordx2 s[6:7], s[0:1], 104
s_load_dwordx2 s[24:25], s[0:1], 0
s_load_dwordx2 s[26:27], s[0:1], 112
s_waitcnt lgkmcnt(0)
s_mov_b32 s16, s6
s_and_b32 s17, s7, 0xffff
s_mov_b32 s18, 1024
s_mov_b32 s19, 0x00020000
s_mov_b32 s28, s24
s_and_b32 s29, s25, 0xffff
s_mov_b32 s30, 2097152
s_mov_b32 s31, 0x00020000
s_mov_b32 s32, s26
s_and_b32 s33, s27, 0xffff
s_mov_b32 s34, 2097152
s_mov_b32 s35, 0x00020000
s_lshl_b32 s20, s13, 6
v_lshl_add_u32 v12, v9, 5, v6
v_add_u32 v12, s20, v12
v_lshlrev_b32 v13, 1, v12
buffer_load_ushort v14, v13, s[16:19], 0 offen
s_lshl_b32 s20, s12, 6
v_lshlrev_b32 v15, 5, v8
v_lshl_add_u32 v15, v7, 2, v15
v_add_u32 v15, s20, v15
v_lshlrev_b32 v16, 12, v12
v_lshl_add_u32 v16, v15, 1, v16
v_lshlrev_b32 v17, 10, v15
v_add_u32 v17, v17, v13
s_mov_b32 s22, 18874368
buffer_load_dwordx2 v[48:49], v16, s[8:11], s22 offen offset:0
s_mov_b32 s23, 0
buffer_load_ushort v32, v17, s[28:31], s23 offen offset:0
buffer_load_ushort v33, v17, s[28:31], s23 offen offset:1024
buffer_load_ushort v34, v17, s[28:31], s23 offen offset:2048
buffer_load_ushort v35, v17, s[28:31], s23 offen offset:3072
buffer_load_dwordx2 v[50:51], v16, s[8:11], s22 offen offset:16
s_mov_b32 s23, 8192
buffer_load_ushort v36, v17, s[28:31], s23 offen offset:0
buffer_load_ushort v37, v17, s[28:31], s23 offen offset:1024
buffer_load_ushort v38, v17, s[28:31], s23 offen offset:2048
buffer_load_ushort v39, v17, s[28:31], s23 offen offset:3072
buffer_load_dwordx2 v[52:53], v16, s[8:11], s22 offen offset:32
s_mov_b32 s23, 16384
buffer_load_ushort v40, v17, s[28:31], s23 offen offset:0
buffer_load_ushort v41, v17, s[28:31], s23 offen offset:1024
buffer_load_ushort v42, v17, s[28:31], s23 offen offset:2048
buffer_load_ushort v43, v17, s[28:31], s23 offen offset:3072
buffer_load_dwordx2 v[54:55], v16, s[8:11], s22 offen offset:48
s_mov_b32 s23, 24576
buffer_load_ushort v44, v17, s[28:31], s23 offen offset:0
buffer_load_ushort v45, v17, s[28:31], s23 offen offset:1024
buffer_load_ushort v46, v17, s[28:31], s23 offen offset:2048
buffer_load_ushort v47, v17, s[28:31], s23 offen offset:3072
s_add_u32 s16, s14, 0
s_add_u32 s37, s36, 0
s_mov_b32 m0, s37
s_nop 0
buffer_load_dwordx4 v112, s[8:11], s16 offen lds
s_add_u32 s37, s36, 1024
s_mov_b32 m0, s37
s_nop 0
buffer_load_dwordx4 v113, s[8:11], s16 offen lds
s_add_u32 s37, s36, 2048
s_mov_b32 m0, s37
s_nop 0
buffer_load_dwordx4 v114, s[8:11], s16 offen lds
s_add_u32 s37, s36, 3072
s_mov_b32 m0, s37
s_nop 0
buffer_load_dwordx4 v115, s[8:11], s16 offen lds
s_add_u32 s16, s15, 0
s_add_u32 s37, s36, 16384
s_mov_b32 m0, s37
s_nop 0
buffer_load_dwordx4 v112, s[8:11], s16 offen lds
s_add_u32 s37, s36, 17408
s_mov_b32 m0, s37
s_nop 0
buffer_load_dwordx4 v113, s[8:11], s16 offen lds
s_add_u32 s37, s36, 18432
s_mov_b32 m0, s37
s_nop 0
buffer_load_dwordx4 v114, s[8:11], s16 offen lds
s_add_u32 s37, s36, 19456
s_mov_b32 m0, s37
s_nop 0
buffer_load_dwordx4 v115, s[8:11], s16 offen lds
s_add_u32 s16, s14, 256
s_add_u32 s37, s36, 32768
s_mov_b32 m0, s37
s_nop 0
buffer_load_dwordx4 v112, s[8:11], s16 offen lds
s_add_u32 s37, s36, 33792
s_mov_b32 m0, s37
s_nop 0
buffer_load_dwordx4 v113, s[8:11], s16 offen lds
s_add_u32 s37, s36, 34816
s_mov_b32 m0, s37
s_nop 0
buffer_load_dwordx4 v114, s[8:11], s16 offen lds
s_add_u32 s37, s36, 35840
s_mov_b32 m0, s37
s_nop 0
buffer_load_dwordx4 v115, s[8:11], s16 offen lds
s_add_u32 s16, s15, 256
s_add_u32 s37, s36, 49152
s_mov_b32 m0, s37
s_nop 0
buffer_load_dwordx4 v112, s[8:11], s16 offen lds
s_add_u32 s37, s36, 50176
s_mov_b32 m0, s37
s_nop 0
buffer_load_dwordx4 v113, s[8:11], s16 offen lds
s_add_u32 s37, s36, 51200
s_mov_b32 m0, s37
s_nop 0
buffer_load_dwordx4 v114, s[8:11], s16 offen lds
s_add_u32 s37, s36, 52224
s_mov_b32 m0, s37
s_nop 0
buffer_load_dwordx4 v115, s[8:11], s16 offen lds
s_add_u32 s16, s14, 512
s_add_u32 s37, s36, 65536
s_mov_b32 m0, s37
s_nop 0
buffer_load_dwordx4 v112, s[8:11], s16 offen lds
s_add_u32 s37, s36, 66560
s_mov_b32 m0, s37
s_nop 0
buffer_load_dwordx4 v113, s[8:11], s16 offen lds
s_add_u32 s37, s36, 67584
s_mov_b32 m0, s37
s_nop 0
buffer_load_dwordx4 v114, s[8:11], s16 offen lds
s_add_u32 s37, s36, 68608
s_mov_b32 m0, s37
s_nop 0
buffer_load_dwordx4 v115, s[8:11], s16 offen lds
s_add_u32 s16, s15, 512
s_add_u32 s37, s36, 81920
s_mov_b32 m0, s37
s_nop 0
buffer_load_dwordx4 v112, s[8:11], s16 offen lds
s_add_u32 s37, s36, 82944
s_mov_b32 m0, s37
s_nop 0
buffer_load_dwordx4 v113, s[8:11], s16 offen lds
s_add_u32 s37, s36, 83968
s_mov_b32 m0, s37
s_nop 0
buffer_load_dwordx4 v114, s[8:11], s16 offen lds
s_add_u32 s37, s36, 84992
s_mov_b32 m0, s37
s_nop 0
buffer_load_dwordx4 v115, s[8:11], s16 offen lds
s_waitcnt vmcnt(16)
s_barrier
s_add_u32 s16, s14, 768
s_add_u32 s37, s36, 98304
s_mov_b32 m0, s37
s_nop 0
buffer_load_dwordx4 v112, s[8:11], s16 offen lds
s_add_u32 s37, s36, 99328
s_mov_b32 m0, s37
s_nop 0
buffer_load_dwordx4 v113, s[8:11], s16 offen lds
s_add_u32 s37, s36, 100352
s_mov_b32 m0, s37
s_nop 0
buffer_load_dwordx4 v114, s[8:11], s16 offen lds
s_add_u32 s37, s36, 101376
s_mov_b32 m0, s37
s_nop 0
buffer_load_dwordx4 v115, s[8:11], s16 offen lds
s_add_u32 s16, s15, 768
s_add_u32 s37, s36, 114688
s_mov_b32 m0, s37
s_nop 0
buffer_load_dwordx4 v112, s[8:11], s16 offen lds
s_add_u32 s37, s36, 115712
s_mov_b32 m0, s37
s_nop 0
buffer_load_dwordx4 v113, s[8:11], s16 offen lds
s_add_u32 s37, s36, 116736
s_mov_b32 m0, s37
s_nop 0
buffer_load_dwordx4 v114, s[8:11], s16 offen lds
s_add_u32 s37, s36, 117760
s_mov_b32 m0, s37
s_nop 0
buffer_load_dwordx4 v115, s[8:11], s16 offen lds
ds_read_b128 v[80:83], v116 offset:0
ds_read_b128 v[84:87], v124 offset:0
ds_read_b128 v[88:91], v117 offset:0
ds_read_b128 v[92:95], v125 offset:0
ds_read_b128 v[96:99], v118 offset:0
ds_read_b128 v[100:103], v126 offset:0
ds_read_b128 v[104:107], v119 offset:0
ds_read_b128 v[108:111], v127 offset:0
s_waitcnt lgkmcnt(6)
v_mfma_f32_32x32x16_bf16 v[64:79], v[80:83], v[84:87], v[64:79]
ds_read_b128 v[80:83], v120 offset:0
ds_read_b128 v[84:87], v128 offset:0
s_waitcnt lgkmcnt(6)
v_mfma_f32_32x32x16_bf16 v[64:79], v[88:91], v[92:95], v[64:79]
ds_read_b128 v[88:91], v121 offset:0
ds_read_b128 v[92:95], v129 offset:0
s_waitcnt lgkmcnt(6)
v_mfma_f32_32x32x16_bf16 v[64:79], v[96:99], v[100:103], v[64:79]
ds_read_b128 v[96:99], v122 offset:0
ds_read_b128 v[100:103], v130 offset:0
s_waitcnt lgkmcnt(6)
v_mfma_f32_32x32x16_bf16 v[64:79], v[104:107], v[108:111], v[64:79]
ds_read_b128 v[104:107], v123 offset:0
ds_read_b128 v[108:111], v131 offset:0
s_waitcnt lgkmcnt(6)
v_mfma_f32_32x32x16_bf16 v[64:79], v[80:83], v[84:87], v[64:79]
s_waitcnt lgkmcnt(4)
v_mfma_f32_32x32x16_bf16 v[64:79], v[88:91], v[92:95], v[64:79]
s_waitcnt lgkmcnt(2)
v_mfma_f32_32x32x16_bf16 v[64:79], v[96:99], v[100:103], v[64:79]
s_waitcnt lgkmcnt(0)
v_mfma_f32_32x32x16_bf16 v[64:79], v[104:107], v[108:111], v[64:79]
s_waitcnt vmcnt(16)
s_barrier
s_add_u32 s16, s14, 1024
s_add_u32 s37, s36, 0
s_mov_b32 m0, s37
s_nop 0
buffer_load_dwordx4 v112, s[8:11], s16 offen lds
s_add_u32 s37, s36, 1024
s_mov_b32 m0, s37
s_nop 0
buffer_load_dwordx4 v113, s[8:11], s16 offen lds
s_add_u32 s37, s36, 2048
s_mov_b32 m0, s37
s_nop 0
buffer_load_dwordx4 v114, s[8:11], s16 offen lds
s_add_u32 s37, s36, 3072
s_mov_b32 m0, s37
s_nop 0
buffer_load_dwordx4 v115, s[8:11], s16 offen lds
s_add_u32 s16, s15, 1024
s_add_u32 s37, s36, 16384
s_mov_b32 m0, s37
s_nop 0
buffer_load_dwordx4 v112, s[8:11], s16 offen lds
s_add_u32 s37, s36, 17408
s_mov_b32 m0, s37
s_nop 0
buffer_load_dwordx4 v113, s[8:11], s16 offen lds
s_add_u32 s37, s36, 18432
s_mov_b32 m0, s37
s_nop 0
buffer_load_dwordx4 v114, s[8:11], s16 offen lds
s_add_u32 s37, s36, 19456
s_mov_b32 m0, s37
s_nop 0
buffer_load_dwordx4 v115, s[8:11], s16 offen lds
ds_read_b128 v[80:83], v116 offset:32768
ds_read_b128 v[84:87], v124 offset:32768
ds_read_b128 v[88:91], v117 offset:32768
ds_read_b128 v[92:95], v125 offset:32768
ds_read_b128 v[96:99], v118 offset:32768
ds_read_b128 v[100:103], v126 offset:32768
ds_read_b128 v[104:107], v119 offset:32768
ds_read_b128 v[108:111], v127 offset:32768
s_waitcnt lgkmcnt(6)
v_mfma_f32_32x32x16_bf16 v[64:79], v[80:83], v[84:87], v[64:79]
ds_read_b128 v[80:83], v120 offset:32768
ds_read_b128 v[84:87], v128 offset:32768
s_waitcnt lgkmcnt(6)
v_mfma_f32_32x32x16_bf16 v[64:79], v[88:91], v[92:95], v[64:79]
ds_read_b128 v[88:91], v121 offset:32768
ds_read_b128 v[92:95], v129 offset:32768
s_waitcnt lgkmcnt(6)
v_mfma_f32_32x32x16_bf16 v[64:79], v[96:99], v[100:103], v[64:79]
ds_read_b128 v[96:99], v122 offset:32768
ds_read_b128 v[100:103], v130 offset:32768
s_waitcnt lgkmcnt(6)
v_mfma_f32_32x32x16_bf16 v[64:79], v[104:107], v[108:111], v[64:79]
ds_read_b128 v[104:107], v123 offset:32768
ds_read_b128 v[108:111], v131 offset:32768
s_waitcnt lgkmcnt(6)
v_mfma_f32_32x32x16_bf16 v[64:79], v[80:83], v[84:87], v[64:79]
s_waitcnt lgkmcnt(4)
v_mfma_f32_32x32x16_bf16 v[64:79], v[88:91], v[92:95], v[64:79]
s_waitcnt lgkmcnt(2)
v_mfma_f32_32x32x16_bf16 v[64:79], v[96:99], v[100:103], v[64:79]
s_waitcnt lgkmcnt(0)
v_mfma_f32_32x32x16_bf16 v[64:79], v[104:107], v[108:111], v[64:79]
s_waitcnt vmcnt(16)
s_barrier
s_add_u32 s16, s14, 1280
s_add_u32 s37, s36, 32768
s_mov_b32 m0, s37
s_nop 0
buffer_load_dwordx4 v112, s[8:11], s16 offen lds
s_add_u32 s37, s36, 33792
s_mov_b32 m0, s37
s_nop 0
buffer_load_dwordx4 v113, s[8:11], s16 offen lds
s_add_u32 s37, s36, 34816
s_mov_b32 m0, s37
s_nop 0
buffer_load_dwordx4 v114, s[8:11], s16 offen lds
s_add_u32 s37, s36, 35840
s_mov_b32 m0, s37
s_nop 0
buffer_load_dwordx4 v115, s[8:11], s16 offen lds
s_add_u32 s16, s15, 1280
s_add_u32 s37, s36, 49152
s_mov_b32 m0, s37
s_nop 0
buffer_load_dwordx4 v112, s[8:11], s16 offen lds
s_add_u32 s37, s36, 50176
s_mov_b32 m0, s37
s_nop 0
buffer_load_dwordx4 v113, s[8:11], s16 offen lds
s_add_u32 s37, s36, 51200
s_mov_b32 m0, s37
s_nop 0
buffer_load_dwordx4 v114, s[8:11], s16 offen lds
s_add_u32 s37, s36, 52224
s_mov_b32 m0, s37
s_nop 0
buffer_load_dwordx4 v115, s[8:11], s16 offen lds
ds_read_b128 v[80:83], v132 offset:0
ds_read_b128 v[84:87], v140 offset:0
ds_read_b128 v[88:91], v133 offset:0
ds_read_b128 v[92:95], v141 offset:0
ds_read_b128 v[96:99], v134 offset:0
ds_read_b128 v[100:103], v142 offset:0
ds_read_b128 v[104:107], v135 offset:0
ds_read_b128 v[108:111], v143 offset:0
s_waitcnt lgkmcnt(6)
v_mfma_f32_32x32x16_bf16 v[64:79], v[80:83], v[84:87], v[64:79]
ds_read_b128 v[80:83], v136 offset:0
ds_read_b128 v[84:87], v144 offset:0
s_waitcnt lgkmcnt(6)
v_mfma_f32_32x32x16_bf16 v[64:79], v[88:91], v[92:95], v[64:79]
ds_read_b128 v[88:91], v137 offset:0
ds_read_b128 v[92:95], v145 offset:0
s_waitcnt lgkmcnt(6)
v_mfma_f32_32x32x16_bf16 v[64:79], v[96:99], v[100:103], v[64:79]
ds_read_b128 v[96:99], v138 offset:0
ds_read_b128 v[100:103], v146 offset:0
s_waitcnt lgkmcnt(6)
v_mfma_f32_32x32x16_bf16 v[64:79], v[104:107], v[108:111], v[64:79]
ds_read_b128 v[104:107], v139 offset:0
ds_read_b128 v[108:111], v147 offset:0
s_waitcnt lgkmcnt(6)
v_mfma_f32_32x32x16_bf16 v[64:79], v[80:83], v[84:87], v[64:79]
s_waitcnt lgkmcnt(4)
v_mfma_f32_32x32x16_bf16 v[64:79], v[88:91], v[92:95], v[64:79]
s_waitcnt lgkmcnt(2)
v_mfma_f32_32x32x16_bf16 v[64:79], v[96:99], v[100:103], v[64:79]
s_waitcnt lgkmcnt(0)
v_mfma_f32_32x32x16_bf16 v[64:79], v[104:107], v[108:111], v[64:79]
s_waitcnt vmcnt(16)
s_barrier
s_add_u32 s16, s14, 1536
s_add_u32 s37, s36, 65536
s_mov_b32 m0, s37
s_nop 0
buffer_load_dwordx4 v112, s[8:11], s16 offen lds
s_add_u32 s37, s36, 66560
s_mov_b32 m0, s37
s_nop 0
buffer_load_dwordx4 v113, s[8:11], s16 offen lds
s_add_u32 s37, s36, 67584
s_mov_b32 m0, s37
s_nop 0
buffer_load_dwordx4 v114, s[8:11], s16 offen lds
s_add_u32 s37, s36, 68608
s_mov_b32 m0, s37
s_nop 0
buffer_load_dwordx4 v115, s[8:11], s16 offen lds
s_add_u32 s16, s15, 1536
s_add_u32 s37, s36, 81920
s_mov_b32 m0, s37
s_nop 0
buffer_load_dwordx4 v112, s[8:11], s16 offen lds
s_add_u32 s37, s36, 82944
s_mov_b32 m0, s37
s_nop 0
buffer_load_dwordx4 v113, s[8:11], s16 offen lds
s_add_u32 s37, s36, 83968
s_mov_b32 m0, s37
s_nop 0
buffer_load_dwordx4 v114, s[8:11], s16 offen lds
s_add_u32 s37, s36, 84992
s_mov_b32 m0, s37
s_nop 0
buffer_load_dwordx4 v115, s[8:11], s16 offen lds
ds_read_b128 v[80:83], v132 offset:32768
ds_read_b128 v[84:87], v140 offset:32768
ds_read_b128 v[88:91], v133 offset:32768
ds_read_b128 v[92:95], v141 offset:32768
ds_read_b128 v[96:99], v134 offset:32768
ds_read_b128 v[100:103], v142 offset:32768
ds_read_b128 v[104:107], v135 offset:32768
ds_read_b128 v[108:111], v143 offset:32768
s_waitcnt lgkmcnt(6)
v_mfma_f32_32x32x16_bf16 v[64:79], v[80:83], v[84:87], v[64:79]
ds_read_b128 v[80:83], v136 offset:32768
ds_read_b128 v[84:87], v144 offset:32768
s_waitcnt lgkmcnt(6)
v_mfma_f32_32x32x16_bf16 v[64:79], v[88:91], v[92:95], v[64:79]
ds_read_b128 v[88:91], v137 offset:32768
ds_read_b128 v[92:95], v145 offset:32768
s_waitcnt lgkmcnt(6)
v_mfma_f32_32x32x16_bf16 v[64:79], v[96:99], v[100:103], v[64:79]
ds_read_b128 v[96:99], v138 offset:32768
ds_read_b128 v[100:103], v146 offset:32768
s_waitcnt lgkmcnt(6)
v_mfma_f32_32x32x16_bf16 v[64:79], v[104:107], v[108:111], v[64:79]
ds_read_b128 v[104:107], v139 offset:32768
ds_read_b128 v[108:111], v147 offset:32768
s_waitcnt lgkmcnt(6)
v_mfma_f32_32x32x16_bf16 v[64:79], v[80:83], v[84:87], v[64:79]
s_waitcnt lgkmcnt(4)
v_mfma_f32_32x32x16_bf16 v[64:79], v[88:91], v[92:95], v[64:79]
s_waitcnt lgkmcnt(2)
v_mfma_f32_32x32x16_bf16 v[64:79], v[96:99], v[100:103], v[64:79]
s_waitcnt lgkmcnt(0)
v_mfma_f32_32x32x16_bf16 v[64:79], v[104:107], v[108:111], v[64:79]
s_waitcnt vmcnt(16)
s_barrier
s_add_u32 s16, s14, 1792
s_add_u32 s37, s36, 98304
s_mov_b32 m0, s37
s_nop 0
buffer_load_dwordx4 v112, s[8:11], s16 offen lds
s_add_u32 s37, s36, 99328
s_mov_b32 m0, s37
s_nop 0
buffer_load_dwordx4 v113, s[8:11], s16 offen lds
s_add_u32 s37, s36, 100352
s_mov_b32 m0, s37
s_nop 0
buffer_load_dwordx4 v114, s[8:11], s16 offen lds
s_add_u32 s37, s36, 101376
s_mov_b32 m0, s37
s_nop 0
buffer_load_dwordx4 v115, s[8:11], s16 offen lds
s_add_u32 s16, s15, 1792
s_add_u32 s37, s36, 114688
s_mov_b32 m0, s37
s_nop 0
buffer_load_dwordx4 v112, s[8:11], s16 offen lds
s_add_u32 s37, s36, 115712
s_mov_b32 m0, s37
s_nop 0
buffer_load_dwordx4 v113, s[8:11], s16 offen lds
s_add_u32 s37, s36, 116736
s_mov_b32 m0, s37
s_nop 0
buffer_load_dwordx4 v114, s[8:11], s16 offen lds
s_add_u32 s37, s36, 117760
s_mov_b32 m0, s37
s_nop 0
buffer_load_dwordx4 v115, s[8:11], s16 offen lds
ds_read_b128 v[80:83], v116 offset:0
ds_read_b128 v[84:87], v124 offset:0
ds_read_b128 v[88:91], v117 offset:0
ds_read_b128 v[92:95], v125 offset:0
ds_read_b128 v[96:99], v118 offset:0
ds_read_b128 v[100:103], v126 offset:0
ds_read_b128 v[104:107], v119 offset:0
ds_read_b128 v[108:111], v127 offset:0
s_waitcnt lgkmcnt(6)
v_mfma_f32_32x32x16_bf16 v[64:79], v[80:83], v[84:87], v[64:79]
ds_read_b128 v[80:83], v120 offset:0
ds_read_b128 v[84:87], v128 offset:0
s_waitcnt lgkmcnt(6)
v_mfma_f32_32x32x16_bf16 v[64:79], v[88:91], v[92:95], v[64:79]
ds_read_b128 v[88:91], v121 offset:0
ds_read_b128 v[92:95], v129 offset:0
s_waitcnt lgkmcnt(6)
v_mfma_f32_32x32x16_bf16 v[64:79], v[96:99], v[100:103], v[64:79]
ds_read_b128 v[96:99], v122 offset:0
ds_read_b128 v[100:103], v130 offset:0
s_waitcnt lgkmcnt(6)
v_mfma_f32_32x32x16_bf16 v[64:79], v[104:107], v[108:111], v[64:79]
ds_read_b128 v[104:107], v123 offset:0
ds_read_b128 v[108:111], v131 offset:0
s_waitcnt lgkmcnt(6)
v_mfma_f32_32x32x16_bf16 v[64:79], v[80:83], v[84:87], v[64:79]
s_waitcnt lgkmcnt(4)
v_mfma_f32_32x32x16_bf16 v[64:79], v[88:91], v[92:95], v[64:79]
s_waitcnt lgkmcnt(2)
v_mfma_f32_32x32x16_bf16 v[64:79], v[96:99], v[100:103], v[64:79]
s_waitcnt lgkmcnt(0)
v_mfma_f32_32x32x16_bf16 v[64:79], v[104:107], v[108:111], v[64:79]
s_waitcnt vmcnt(16)
s_barrier
s_add_u32 s16, s14, 2048
s_add_u32 s37, s36, 0
s_mov_b32 m0, s37
s_nop 0
buffer_load_dwordx4 v112, s[8:11], s16 offen lds
s_add_u32 s37, s36, 1024
s_mov_b32 m0, s37
s_nop 0
buffer_load_dwordx4 v113, s[8:11], s16 offen lds
s_add_u32 s37, s36, 2048
s_mov_b32 m0, s37
s_nop 0
buffer_load_dwordx4 v114, s[8:11], s16 offen lds
s_add_u32 s37, s36, 3072
s_mov_b32 m0, s37
s_nop 0
buffer_load_dwordx4 v115, s[8:11], s16 offen lds
s_add_u32 s16, s15, 2048
s_add_u32 s37, s36, 16384
s_mov_b32 m0, s37
s_nop 0
buffer_load_dwordx4 v112, s[8:11], s16 offen lds
s_add_u32 s37, s36, 17408
s_mov_b32 m0, s37
s_nop 0
buffer_load_dwordx4 v113, s[8:11], s16 offen lds
s_add_u32 s37, s36, 18432
s_mov_b32 m0, s37
s_nop 0
buffer_load_dwordx4 v114, s[8:11], s16 offen lds
s_add_u32 s37, s36, 19456
s_mov_b32 m0, s37
s_nop 0
buffer_load_dwordx4 v115, s[8:11], s16 offen lds
ds_read_b128 v[80:83], v116 offset:32768
ds_read_b128 v[84:87], v124 offset:32768
ds_read_b128 v[88:91], v117 offset:32768
ds_read_b128 v[92:95], v125 offset:32768
ds_read_b128 v[96:99], v118 offset:32768
ds_read_b128 v[100:103], v126 offset:32768
ds_read_b128 v[104:107], v119 offset:32768
ds_read_b128 v[108:111], v127 offset:32768
s_waitcnt lgkmcnt(6)
v_mfma_f32_32x32x16_bf16 v[64:79], v[80:83], v[84:87], v[64:79]
ds_read_b128 v[80:83], v120 offset:32768
ds_read_b128 v[84:87], v128 offset:32768
s_waitcnt lgkmcnt(6)
v_mfma_f32_32x32x16_bf16 v[64:79], v[88:91], v[92:95], v[64:79]
ds_read_b128 v[88:91], v121 offset:32768
ds_read_b128 v[92:95], v129 offset:32768
s_waitcnt lgkmcnt(6)
v_mfma_f32_32x32x16_bf16 v[64:79], v[96:99], v[100:103], v[64:79]
ds_read_b128 v[96:99], v122 offset:32768
ds_read_b128 v[100:103], v130 offset:32768
s_waitcnt lgkmcnt(6)
v_mfma_f32_32x32x16_bf16 v[64:79], v[104:107], v[108:111], v[64:79]
ds_read_b128 v[104:107], v123 offset:32768
ds_read_b128 v[108:111], v131 offset:32768
s_waitcnt lgkmcnt(6)
v_mfma_f32_32x32x16_bf16 v[64:79], v[80:83], v[84:87], v[64:79]
s_waitcnt lgkmcnt(4)
v_mfma_f32_32x32x16_bf16 v[64:79], v[88:91], v[92:95], v[64:79]
s_waitcnt lgkmcnt(2)
v_mfma_f32_32x32x16_bf16 v[64:79], v[96:99], v[100:103], v[64:79]
s_waitcnt lgkmcnt(0)
v_mfma_f32_32x32x16_bf16 v[64:79], v[104:107], v[108:111], v[64:79]
s_waitcnt vmcnt(16)
s_barrier
s_add_u32 s16, s14, 2304
s_add_u32 s37, s36, 32768
s_mov_b32 m0, s37
s_nop 0
buffer_load_dwordx4 v112, s[8:11], s16 offen lds
s_add_u32 s37, s36, 33792
s_mov_b32 m0, s37
s_nop 0
buffer_load_dwordx4 v113, s[8:11], s16 offen lds
s_add_u32 s37, s36, 34816
s_mov_b32 m0, s37
s_nop 0
buffer_load_dwordx4 v114, s[8:11], s16 offen lds
s_add_u32 s37, s36, 35840
s_mov_b32 m0, s37
s_nop 0
buffer_load_dwordx4 v115, s[8:11], s16 offen lds
s_add_u32 s16, s15, 2304
s_add_u32 s37, s36, 49152
s_mov_b32 m0, s37
s_nop 0
buffer_load_dwordx4 v112, s[8:11], s16 offen lds
s_add_u32 s37, s36, 50176
s_mov_b32 m0, s37
s_nop 0
buffer_load_dwordx4 v113, s[8:11], s16 offen lds
s_add_u32 s37, s36, 51200
s_mov_b32 m0, s37
s_nop 0
buffer_load_dwordx4 v114, s[8:11], s16 offen lds
s_add_u32 s37, s36, 52224
s_mov_b32 m0, s37
s_nop 0
buffer_load_dwordx4 v115, s[8:11], s16 offen lds
ds_read_b128 v[80:83], v132 offset:0
ds_read_b128 v[84:87], v140 offset:0
ds_read_b128 v[88:91], v133 offset:0
ds_read_b128 v[92:95], v141 offset:0
ds_read_b128 v[96:99], v134 offset:0
ds_read_b128 v[100:103], v142 offset:0
ds_read_b128 v[104:107], v135 offset:0
ds_read_b128 v[108:111], v143 offset:0
s_waitcnt lgkmcnt(6)
v_mfma_f32_32x32x16_bf16 v[64:79], v[80:83], v[84:87], v[64:79]
ds_read_b128 v[80:83], v136 offset:0
ds_read_b128 v[84:87], v144 offset:0
s_waitcnt lgkmcnt(6)
v_mfma_f32_32x32x16_bf16 v[64:79], v[88:91], v[92:95], v[64:79]
ds_read_b128 v[88:91], v137 offset:0
ds_read_b128 v[92:95], v145 offset:0
s_waitcnt lgkmcnt(6)
v_mfma_f32_32x32x16_bf16 v[64:79], v[96:99], v[100:103], v[64:79]
ds_read_b128 v[96:99], v138 offset:0
ds_read_b128 v[100:103], v146 offset:0
s_waitcnt lgkmcnt(6)
v_mfma_f32_32x32x16_bf16 v[64:79], v[104:107], v[108:111], v[64:79]
ds_read_b128 v[104:107], v139 offset:0
ds_read_b128 v[108:111], v147 offset:0
s_waitcnt lgkmcnt(6)
v_mfma_f32_32x32x16_bf16 v[64:79], v[80:83], v[84:87], v[64:79]
s_waitcnt lgkmcnt(4)
v_mfma_f32_32x32x16_bf16 v[64:79], v[88:91], v[92:95], v[64:79]
s_waitcnt lgkmcnt(2)
v_mfma_f32_32x32x16_bf16 v[64:79], v[96:99], v[100:103], v[64:79]
s_waitcnt lgkmcnt(0)
v_mfma_f32_32x32x16_bf16 v[64:79], v[104:107], v[108:111], v[64:79]
s_waitcnt vmcnt(16)
s_barrier
s_add_u32 s16, s14, 2560
s_add_u32 s37, s36, 65536
s_mov_b32 m0, s37
s_nop 0
buffer_load_dwordx4 v112, s[8:11], s16 offen lds
s_add_u32 s37, s36, 66560
s_mov_b32 m0, s37
s_nop 0
buffer_load_dwordx4 v113, s[8:11], s16 offen lds
s_add_u32 s37, s36, 67584
s_mov_b32 m0, s37
s_nop 0
buffer_load_dwordx4 v114, s[8:11], s16 offen lds
s_add_u32 s37, s36, 68608
s_mov_b32 m0, s37
s_nop 0
buffer_load_dwordx4 v115, s[8:11], s16 offen lds
s_add_u32 s16, s15, 2560
s_add_u32 s37, s36, 81920
s_mov_b32 m0, s37
s_nop 0
buffer_load_dwordx4 v112, s[8:11], s16 offen lds
s_add_u32 s37, s36, 82944
s_mov_b32 m0, s37
s_nop 0
buffer_load_dwordx4 v113, s[8:11], s16 offen lds
s_add_u32 s37, s36, 83968
s_mov_b32 m0, s37
s_nop 0
buffer_load_dwordx4 v114, s[8:11], s16 offen lds
s_add_u32 s37, s36, 84992
s_mov_b32 m0, s37
s_nop 0
buffer_load_dwordx4 v115, s[8:11], s16 offen lds
ds_read_b128 v[80:83], v132 offset:32768
ds_read_b128 v[84:87], v140 offset:32768
ds_read_b128 v[88:91], v133 offset:32768
ds_read_b128 v[92:95], v141 offset:32768
ds_read_b128 v[96:99], v134 offset:32768
ds_read_b128 v[100:103], v142 offset:32768
ds_read_b128 v[104:107], v135 offset:32768
ds_read_b128 v[108:111], v143 offset:32768
s_waitcnt lgkmcnt(6)
v_mfma_f32_32x32x16_bf16 v[64:79], v[80:83], v[84:87], v[64:79]
ds_read_b128 v[80:83], v136 offset:32768
ds_read_b128 v[84:87], v144 offset:32768
s_waitcnt lgkmcnt(6)
v_mfma_f32_32x32x16_bf16 v[64:79], v[88:91], v[92:95], v[64:79]
ds_read_b128 v[88:91], v137 offset:32768
ds_read_b128 v[92:95], v145 offset:32768
s_waitcnt lgkmcnt(6)
v_mfma_f32_32x32x16_bf16 v[64:79], v[96:99], v[100:103], v[64:79]
ds_read_b128 v[96:99], v138 offset:32768
ds_read_b128 v[100:103], v146 offset:32768
s_waitcnt lgkmcnt(6)
v_mfma_f32_32x32x16_bf16 v[64:79], v[104:107], v[108:111], v[64:79]
ds_read_b128 v[104:107], v139 offset:32768
ds_read_b128 v[108:111], v147 offset:32768
s_waitcnt lgkmcnt(6)
v_mfma_f32_32x32x16_bf16 v[64:79], v[80:83], v[84:87], v[64:79]
s_waitcnt lgkmcnt(4)
v_mfma_f32_32x32x16_bf16 v[64:79], v[88:91], v[92:95], v[64:79]
s_waitcnt lgkmcnt(2)
v_mfma_f32_32x32x16_bf16 v[64:79], v[96:99], v[100:103], v[64:79]
s_waitcnt lgkmcnt(0)
v_mfma_f32_32x32x16_bf16 v[64:79], v[104:107], v[108:111], v[64:79]
s_waitcnt vmcnt(16)
s_barrier
s_add_u32 s16, s14, 2816
s_add_u32 s37, s36, 98304
s_mov_b32 m0, s37
s_nop 0
buffer_load_dwordx4 v112, s[8:11], s16 offen lds
s_add_u32 s37, s36, 99328
s_mov_b32 m0, s37
s_nop 0
buffer_load_dwordx4 v113, s[8:11], s16 offen lds
s_add_u32 s37, s36, 100352
s_mov_b32 m0, s37
s_nop 0
buffer_load_dwordx4 v114, s[8:11], s16 offen lds
s_add_u32 s37, s36, 101376
s_mov_b32 m0, s37
s_nop 0
buffer_load_dwordx4 v115, s[8:11], s16 offen lds
s_add_u32 s16, s15, 2816
s_add_u32 s37, s36, 114688
s_mov_b32 m0, s37
s_nop 0
buffer_load_dwordx4 v112, s[8:11], s16 offen lds
s_add_u32 s37, s36, 115712
s_mov_b32 m0, s37
s_nop 0
buffer_load_dwordx4 v113, s[8:11], s16 offen lds
s_add_u32 s37, s36, 116736
s_mov_b32 m0, s37
s_nop 0
buffer_load_dwordx4 v114, s[8:11], s16 offen lds
s_add_u32 s37, s36, 117760
s_mov_b32 m0, s37
s_nop 0
buffer_load_dwordx4 v115, s[8:11], s16 offen lds
ds_read_b128 v[80:83], v116 offset:0
ds_read_b128 v[84:87], v124 offset:0
ds_read_b128 v[88:91], v117 offset:0
ds_read_b128 v[92:95], v125 offset:0
ds_read_b128 v[96:99], v118 offset:0
ds_read_b128 v[100:103], v126 offset:0
ds_read_b128 v[104:107], v119 offset:0
ds_read_b128 v[108:111], v127 offset:0
s_waitcnt lgkmcnt(6)
v_mfma_f32_32x32x16_bf16 v[64:79], v[80:83], v[84:87], v[64:79]
ds_read_b128 v[80:83], v120 offset:0
ds_read_b128 v[84:87], v128 offset:0
s_waitcnt lgkmcnt(6)
v_mfma_f32_32x32x16_bf16 v[64:79], v[88:91], v[92:95], v[64:79]
ds_read_b128 v[88:91], v121 offset:0
ds_read_b128 v[92:95], v129 offset:0
s_waitcnt lgkmcnt(6)
v_mfma_f32_32x32x16_bf16 v[64:79], v[96:99], v[100:103], v[64:79]
ds_read_b128 v[96:99], v122 offset:0
ds_read_b128 v[100:103], v130 offset:0
s_waitcnt lgkmcnt(6)
v_mfma_f32_32x32x16_bf16 v[64:79], v[104:107], v[108:111], v[64:79]
ds_read_b128 v[104:107], v123 offset:0
ds_read_b128 v[108:111], v131 offset:0
s_waitcnt lgkmcnt(6)
v_mfma_f32_32x32x16_bf16 v[64:79], v[80:83], v[84:87], v[64:79]
s_waitcnt lgkmcnt(4)
v_mfma_f32_32x32x16_bf16 v[64:79], v[88:91], v[92:95], v[64:79]
s_waitcnt lgkmcnt(2)
v_mfma_f32_32x32x16_bf16 v[64:79], v[96:99], v[100:103], v[64:79]
s_waitcnt lgkmcnt(0)
v_mfma_f32_32x32x16_bf16 v[64:79], v[104:107], v[108:111], v[64:79]
s_waitcnt vmcnt(16)
s_barrier
s_add_u32 s16, s14, 3072
s_add_u32 s37, s36, 0
s_mov_b32 m0, s37
s_nop 0
buffer_load_dwordx4 v112, s[8:11], s16 offen lds
s_add_u32 s37, s36, 1024
s_mov_b32 m0, s37
s_nop 0
buffer_load_dwordx4 v113, s[8:11], s16 offen lds
s_add_u32 s37, s36, 2048
s_mov_b32 m0, s37
s_nop 0
buffer_load_dwordx4 v114, s[8:11], s16 offen lds
s_add_u32 s37, s36, 3072
s_mov_b32 m0, s37
s_nop 0
buffer_load_dwordx4 v115, s[8:11], s16 offen lds
s_add_u32 s16, s15, 3072
s_add_u32 s37, s36, 16384
s_mov_b32 m0, s37
s_nop 0
buffer_load_dwordx4 v112, s[8:11], s16 offen lds
s_add_u32 s37, s36, 17408
s_mov_b32 m0, s37
s_nop 0
buffer_load_dwordx4 v113, s[8:11], s16 offen lds
s_add_u32 s37, s36, 18432
s_mov_b32 m0, s37
s_nop 0
buffer_load_dwordx4 v114, s[8:11], s16 offen lds
s_add_u32 s37, s36, 19456
s_mov_b32 m0, s37
s_nop 0
buffer_load_dwordx4 v115, s[8:11], s16 offen lds
ds_read_b128 v[80:83], v116 offset:32768
ds_read_b128 v[84:87], v124 offset:32768
ds_read_b128 v[88:91], v117 offset:32768
ds_read_b128 v[92:95], v125 offset:32768
ds_read_b128 v[96:99], v118 offset:32768
ds_read_b128 v[100:103], v126 offset:32768
ds_read_b128 v[104:107], v119 offset:32768
ds_read_b128 v[108:111], v127 offset:32768
s_waitcnt lgkmcnt(6)
v_mfma_f32_32x32x16_bf16 v[64:79], v[80:83], v[84:87], v[64:79]
ds_read_b128 v[80:83], v120 offset:32768
ds_read_b128 v[84:87], v128 offset:32768
s_waitcnt lgkmcnt(6)
v_mfma_f32_32x32x16_bf16 v[64:79], v[88:91], v[92:95], v[64:79]
ds_read_b128 v[88:91], v121 offset:32768
ds_read_b128 v[92:95], v129 offset:32768
s_waitcnt lgkmcnt(6)
v_mfma_f32_32x32x16_bf16 v[64:79], v[96:99], v[100:103], v[64:79]
ds_read_b128 v[96:99], v122 offset:32768
ds_read_b128 v[100:103], v130 offset:32768
s_waitcnt lgkmcnt(6)
v_mfma_f32_32x32x16_bf16 v[64:79], v[104:107], v[108:111], v[64:79]
ds_read_b128 v[104:107], v123 offset:32768
ds_read_b128 v[108:111], v131 offset:32768
s_waitcnt lgkmcnt(6)
v_mfma_f32_32x32x16_bf16 v[64:79], v[80:83], v[84:87], v[64:79]
s_waitcnt lgkmcnt(4)
v_mfma_f32_32x32x16_bf16 v[64:79], v[88:91], v[92:95], v[64:79]
s_waitcnt lgkmcnt(2)
v_mfma_f32_32x32x16_bf16 v[64:79], v[96:99], v[100:103], v[64:79]
s_waitcnt lgkmcnt(0)
v_mfma_f32_32x32x16_bf16 v[64:79], v[104:107], v[108:111], v[64:79]
s_waitcnt vmcnt(16)
s_barrier
s_add_u32 s16, s14, 3328
s_add_u32 s37, s36, 32768
s_mov_b32 m0, s37
s_nop 0
buffer_load_dwordx4 v112, s[8:11], s16 offen lds
s_add_u32 s37, s36, 33792
s_mov_b32 m0, s37
s_nop 0
buffer_load_dwordx4 v113, s[8:11], s16 offen lds
s_add_u32 s37, s36, 34816
s_mov_b32 m0, s37
s_nop 0
buffer_load_dwordx4 v114, s[8:11], s16 offen lds
s_add_u32 s37, s36, 35840
s_mov_b32 m0, s37
s_nop 0
buffer_load_dwordx4 v115, s[8:11], s16 offen lds
s_add_u32 s16, s15, 3328
s_add_u32 s37, s36, 49152
s_mov_b32 m0, s37
s_nop 0
buffer_load_dwordx4 v112, s[8:11], s16 offen lds
s_add_u32 s37, s36, 50176
s_mov_b32 m0, s37
s_nop 0
buffer_load_dwordx4 v113, s[8:11], s16 offen lds
s_add_u32 s37, s36, 51200
s_mov_b32 m0, s37
s_nop 0
buffer_load_dwordx4 v114, s[8:11], s16 offen lds
s_add_u32 s37, s36, 52224
s_mov_b32 m0, s37
s_nop 0
buffer_load_dwordx4 v115, s[8:11], s16 offen lds
ds_read_b128 v[80:83], v132 offset:0
ds_read_b128 v[84:87], v140 offset:0
ds_read_b128 v[88:91], v133 offset:0
ds_read_b128 v[92:95], v141 offset:0
ds_read_b128 v[96:99], v134 offset:0
ds_read_b128 v[100:103], v142 offset:0
ds_read_b128 v[104:107], v135 offset:0
ds_read_b128 v[108:111], v143 offset:0
s_waitcnt lgkmcnt(6)
v_mfma_f32_32x32x16_bf16 v[64:79], v[80:83], v[84:87], v[64:79]
ds_read_b128 v[80:83], v136 offset:0
ds_read_b128 v[84:87], v144 offset:0
s_waitcnt lgkmcnt(6)
v_mfma_f32_32x32x16_bf16 v[64:79], v[88:91], v[92:95], v[64:79]
ds_read_b128 v[88:91], v137 offset:0
ds_read_b128 v[92:95], v145 offset:0
s_waitcnt lgkmcnt(6)
v_mfma_f32_32x32x16_bf16 v[64:79], v[96:99], v[100:103], v[64:79]
ds_read_b128 v[96:99], v138 offset:0
ds_read_b128 v[100:103], v146 offset:0
s_waitcnt lgkmcnt(6)
v_mfma_f32_32x32x16_bf16 v[64:79], v[104:107], v[108:111], v[64:79]
ds_read_b128 v[104:107], v139 offset:0
ds_read_b128 v[108:111], v147 offset:0
s_waitcnt lgkmcnt(6)
v_mfma_f32_32x32x16_bf16 v[64:79], v[80:83], v[84:87], v[64:79]
s_waitcnt lgkmcnt(4)
v_mfma_f32_32x32x16_bf16 v[64:79], v[88:91], v[92:95], v[64:79]
s_waitcnt lgkmcnt(2)
v_mfma_f32_32x32x16_bf16 v[64:79], v[96:99], v[100:103], v[64:79]
s_waitcnt lgkmcnt(0)
v_mfma_f32_32x32x16_bf16 v[64:79], v[104:107], v[108:111], v[64:79]
s_waitcnt vmcnt(16)
s_barrier
ds_read_b128 v[80:83], v132 offset:32768
ds_read_b128 v[84:87], v140 offset:32768
ds_read_b128 v[88:91], v133 offset:32768
ds_read_b128 v[92:95], v141 offset:32768
ds_read_b128 v[96:99], v134 offset:32768
ds_read_b128 v[100:103], v142 offset:32768
ds_read_b128 v[104:107], v135 offset:32768
ds_read_b128 v[108:111], v143 offset:32768
s_waitcnt lgkmcnt(6)
v_mfma_f32_32x32x16_bf16 v[64:79], v[80:83], v[84:87], v[64:79]
ds_read_b128 v[80:83], v136 offset:32768
ds_read_b128 v[84:87], v144 offset:32768
s_waitcnt lgkmcnt(6)
v_mfma_f32_32x32x16_bf16 v[64:79], v[88:91], v[92:95], v[64:79]
ds_read_b128 v[88:91], v137 offset:32768
ds_read_b128 v[92:95], v145 offset:32768
s_waitcnt lgkmcnt(6)
v_mfma_f32_32x32x16_bf16 v[64:79], v[96:99], v[100:103], v[64:79]
ds_read_b128 v[96:99], v138 offset:32768
ds_read_b128 v[100:103], v146 offset:32768
s_waitcnt lgkmcnt(6)
v_mfma_f32_32x32x16_bf16 v[64:79], v[104:107], v[108:111], v[64:79]
ds_read_b128 v[104:107], v139 offset:32768
ds_read_b128 v[108:111], v147 offset:32768
s_waitcnt lgkmcnt(6)
v_mfma_f32_32x32x16_bf16 v[64:79], v[80:83], v[84:87], v[64:79]
s_waitcnt lgkmcnt(4)
v_mfma_f32_32x32x16_bf16 v[64:79], v[88:91], v[92:95], v[64:79]
s_waitcnt lgkmcnt(2)
v_mfma_f32_32x32x16_bf16 v[64:79], v[96:99], v[100:103], v[64:79]
s_waitcnt lgkmcnt(0)
v_mfma_f32_32x32x16_bf16 v[64:79], v[104:107], v[108:111], v[64:79]
s_waitcnt vmcnt(8)
s_barrier
ds_read_b128 v[80:83], v116 offset:0
ds_read_b128 v[84:87], v124 offset:0
ds_read_b128 v[88:91], v117 offset:0
ds_read_b128 v[92:95], v125 offset:0
ds_read_b128 v[96:99], v118 offset:0
ds_read_b128 v[100:103], v126 offset:0
ds_read_b128 v[104:107], v119 offset:0
ds_read_b128 v[108:111], v127 offset:0
s_waitcnt lgkmcnt(6)
v_mfma_f32_32x32x16_bf16 v[64:79], v[80:83], v[84:87], v[64:79]
ds_read_b128 v[80:83], v120 offset:0
ds_read_b128 v[84:87], v128 offset:0
s_waitcnt lgkmcnt(6)
v_mfma_f32_32x32x16_bf16 v[64:79], v[88:91], v[92:95], v[64:79]
ds_read_b128 v[88:91], v121 offset:0
ds_read_b128 v[92:95], v129 offset:0
s_waitcnt lgkmcnt(6)
v_mfma_f32_32x32x16_bf16 v[64:79], v[96:99], v[100:103], v[64:79]
ds_read_b128 v[96:99], v122 offset:0
ds_read_b128 v[100:103], v130 offset:0
s_waitcnt lgkmcnt(6)
v_mfma_f32_32x32x16_bf16 v[64:79], v[104:107], v[108:111], v[64:79]
ds_read_b128 v[104:107], v123 offset:0
ds_read_b128 v[108:111], v131 offset:0
s_waitcnt lgkmcnt(6)
v_mfma_f32_32x32x16_bf16 v[64:79], v[80:83], v[84:87], v[64:79]
s_waitcnt lgkmcnt(4)
v_mfma_f32_32x32x16_bf16 v[64:79], v[88:91], v[92:95], v[64:79]
s_waitcnt lgkmcnt(2)
v_mfma_f32_32x32x16_bf16 v[64:79], v[96:99], v[100:103], v[64:79]
s_waitcnt lgkmcnt(0)
v_mfma_f32_32x32x16_bf16 v[64:79], v[104:107], v[108:111], v[64:79]
s_waitcnt vmcnt(0)
s_barrier
ds_read_b128 v[80:83], v116 offset:32768
ds_read_b128 v[84:87], v124 offset:32768
ds_read_b128 v[88:91], v117 offset:32768
ds_read_b128 v[92:95], v125 offset:32768
ds_read_b128 v[96:99], v118 offset:32768
ds_read_b128 v[100:103], v126 offset:32768
ds_read_b128 v[104:107], v119 offset:32768
ds_read_b128 v[108:111], v127 offset:32768
s_waitcnt lgkmcnt(6)
v_mfma_f32_32x32x16_bf16 v[64:79], v[80:83], v[84:87], v[64:79]
ds_read_b128 v[80:83], v120 offset:32768
ds_read_b128 v[84:87], v128 offset:32768
s_waitcnt lgkmcnt(6)
v_mfma_f32_32x32x16_bf16 v[64:79], v[88:91], v[92:95], v[64:79]
ds_read_b128 v[88:91], v121 offset:32768
ds_read_b128 v[92:95], v129 offset:32768
s_waitcnt lgkmcnt(6)
v_mfma_f32_32x32x16_bf16 v[64:79], v[96:99], v[100:103], v[64:79]
ds_read_b128 v[96:99], v122 offset:32768
ds_read_b128 v[100:103], v130 offset:32768
s_waitcnt lgkmcnt(6)
v_mfma_f32_32x32x16_bf16 v[64:79], v[104:107], v[108:111], v[64:79]
ds_read_b128 v[104:107], v123 offset:32768
ds_read_b128 v[108:111], v131 offset:32768
s_waitcnt lgkmcnt(6)
v_mfma_f32_32x32x16_bf16 v[64:79], v[80:83], v[84:87], v[64:79]
s_waitcnt lgkmcnt(4)
v_mfma_f32_32x32x16_bf16 v[64:79], v[88:91], v[92:95], v[64:79]
s_waitcnt lgkmcnt(2)
v_mfma_f32_32x32x16_bf16 v[64:79], v[96:99], v[100:103], v[64:79]
s_waitcnt lgkmcnt(0)
v_mfma_f32_32x32x16_bf16 v[64:79], v[104:107], v[108:111], v[64:79]
s_nop 15
s_nop 7
v_lshlrev_b32 v14, 16, v14
v_mov_b32 v24, v64
v_lshlrev_b32 v20, 16, v32
v_mov_b32 v25, v65
v_lshlrev_b32 v21, 16, v33
v_mov_b32 v26, v66
v_lshlrev_b32 v22, 16, v34
v_mov_b32 v27, v67
v_lshlrev_b32 v23, 16, v35
v_cvt_pk_bf16_f32 v30, v24, v25
v_lshlrev_b32 v24, 16, v30
v_and_b32 v25, 0xffff0000, v30
v_cvt_pk_bf16_f32 v30, v26, v27
v_lshlrev_b32 v26, 16, v30
v_and_b32 v27, 0xffff0000, v30
v_add_f32 v24, v24, v14
v_add_f32 v25, v25, v14
v_add_f32 v26, v26, v14
v_add_f32 v27, v27, v14
v_cvt_pk_bf16_f32 v30, v24, v25
v_lshlrev_b32 v24, 16, v30
v_and_b32 v25, 0xffff0000, v30
v_cvt_pk_bf16_f32 v30, v26, v27
v_lshlrev_b32 v26, 16, v30
v_and_b32 v27, 0xffff0000, v30
v_lshlrev_b32 v31, 16, v48
v_add_f32 v20, v20, v31
v_and_b32 v31, 0xffff0000, v48
v_add_f32 v21, v21, v31
v_lshlrev_b32 v31, 16, v49
v_add_f32 v22, v22, v31
v_and_b32 v31, 0xffff0000, v49
v_add_f32 v23, v23, v31
v_cvt_pk_bf16_f32 v30, v20, v21
v_lshlrev_b32 v20, 16, v30
v_and_b32 v21, 0xffff0000, v30
v_cvt_pk_bf16_f32 v30, v22, v23
v_lshlrev_b32 v22, 16, v30
v_and_b32 v23, 0xffff0000, v30
v_add_f32 v24, v24, v20
v_add_f32 v25, v25, v21
v_add_f32 v26, v26, v22
v_add_f32 v27, v27, v23
v_cvt_pk_bf16_f32 v56, v24, v25
v_cvt_pk_bf16_f32 v57, v26, v27
s_mov_b32 s23, 0
buffer_store_short v56, v17, s[32:35], s23 offen offset:0
buffer_store_short_d16_hi v56, v17, s[32:35], s23 offen offset:1024
buffer_store_short v57, v17, s[32:35], s23 offen offset:2048
buffer_store_short_d16_hi v57, v17, s[32:35], s23 offen offset:3072
v_mov_b32 v24, v68
v_lshlrev_b32 v20, 16, v36
v_mov_b32 v25, v69
v_lshlrev_b32 v21, 16, v37
v_mov_b32 v26, v70
v_lshlrev_b32 v22, 16, v38
v_mov_b32 v27, v71
v_lshlrev_b32 v23, 16, v39
v_cvt_pk_bf16_f32 v30, v24, v25
v_lshlrev_b32 v24, 16, v30
v_and_b32 v25, 0xffff0000, v30
v_cvt_pk_bf16_f32 v30, v26, v27
v_lshlrev_b32 v26, 16, v30
v_and_b32 v27, 0xffff0000, v30
v_add_f32 v24, v24, v14
v_add_f32 v25, v25, v14
v_add_f32 v26, v26, v14
v_add_f32 v27, v27, v14
v_cvt_pk_bf16_f32 v30, v24, v25
v_lshlrev_b32 v24, 16, v30
v_and_b32 v25, 0xffff0000, v30
v_cvt_pk_bf16_f32 v30, v26, v27
v_lshlrev_b32 v26, 16, v30
v_and_b32 v27, 0xffff0000, v30
v_lshlrev_b32 v31, 16, v50
v_add_f32 v20, v20, v31
v_and_b32 v31, 0xffff0000, v50
v_add_f32 v21, v21, v31
v_lshlrev_b32 v31, 16, v51
v_add_f32 v22, v22, v31
v_and_b32 v31, 0xffff0000, v51
v_add_f32 v23, v23, v31
v_cvt_pk_bf16_f32 v30, v20, v21
v_lshlrev_b32 v20, 16, v30
v_and_b32 v21, 0xffff0000, v30
v_cvt_pk_bf16_f32 v30, v22, v23
v_lshlrev_b32 v22, 16, v30
v_and_b32 v23, 0xffff0000, v30
v_add_f32 v24, v24, v20
v_add_f32 v25, v25, v21
v_add_f32 v26, v26, v22
v_add_f32 v27, v27, v23
v_cvt_pk_bf16_f32 v58, v24, v25
v_cvt_pk_bf16_f32 v59, v26, v27
s_mov_b32 s23, 8192
buffer_store_short v58, v17, s[32:35], s23 offen offset:0
buffer_store_short_d16_hi v58, v17, s[32:35], s23 offen offset:1024
buffer_store_short v59, v17, s[32:35], s23 offen offset:2048
buffer_store_short_d16_hi v59, v17, s[32:35], s23 offen offset:3072
v_mov_b32 v24, v72
v_lshlrev_b32 v20, 16, v40
v_mov_b32 v25, v73
v_lshlrev_b32 v21, 16, v41
v_mov_b32 v26, v74
v_lshlrev_b32 v22, 16, v42
v_mov_b32 v27, v75
v_lshlrev_b32 v23, 16, v43
v_cvt_pk_bf16_f32 v30, v24, v25
v_lshlrev_b32 v24, 16, v30
v_and_b32 v25, 0xffff0000, v30
v_cvt_pk_bf16_f32 v30, v26, v27
v_lshlrev_b32 v26, 16, v30
v_and_b32 v27, 0xffff0000, v30
v_add_f32 v24, v24, v14
v_add_f32 v25, v25, v14
v_add_f32 v26, v26, v14
v_add_f32 v27, v27, v14
v_cvt_pk_bf16_f32 v30, v24, v25
v_lshlrev_b32 v24, 16, v30
v_and_b32 v25, 0xffff0000, v30
v_cvt_pk_bf16_f32 v30, v26, v27
v_lshlrev_b32 v26, 16, v30
v_and_b32 v27, 0xffff0000, v30
v_lshlrev_b32 v31, 16, v52
v_add_f32 v20, v20, v31
v_and_b32 v31, 0xffff0000, v52
v_add_f32 v21, v21, v31
v_lshlrev_b32 v31, 16, v53
v_add_f32 v22, v22, v31
v_and_b32 v31, 0xffff0000, v53
v_add_f32 v23, v23, v31
v_cvt_pk_bf16_f32 v30, v20, v21
v_lshlrev_b32 v20, 16, v30
v_and_b32 v21, 0xffff0000, v30
v_cvt_pk_bf16_f32 v30, v22, v23
v_lshlrev_b32 v22, 16, v30
v_and_b32 v23, 0xffff0000, v30
v_add_f32 v24, v24, v20
v_add_f32 v25, v25, v21
v_add_f32 v26, v26, v22
v_add_f32 v27, v27, v23
v_cvt_pk_bf16_f32 v60, v24, v25
v_cvt_pk_bf16_f32 v61, v26, v27
s_mov_b32 s23, 16384
buffer_store_short v60, v17, s[32:35], s23 offen offset:0
buffer_store_short_d16_hi v60, v17, s[32:35], s23 offen offset:1024
buffer_store_short v61, v17, s[32:35], s23 offen offset:2048
buffer_store_short_d16_hi v61, v17, s[32:35], s23 offen offset:3072
v_mov_b32 v24, v76
v_lshlrev_b32 v20, 16, v44
v_mov_b32 v25, v77
v_lshlrev_b32 v21, 16, v45
v_mov_b32 v26, v78
v_lshlrev_b32 v22, 16, v46
v_mov_b32 v27, v79
v_lshlrev_b32 v23, 16, v47
v_cvt_pk_bf16_f32 v30, v24, v25
v_lshlrev_b32 v24, 16, v30
v_and_b32 v25, 0xffff0000, v30
v_cvt_pk_bf16_f32 v30, v26, v27
v_lshlrev_b32 v26, 16, v30
v_and_b32 v27, 0xffff0000, v30
v_add_f32 v24, v24, v14
v_add_f32 v25, v25, v14
v_add_f32 v26, v26, v14
v_add_f32 v27, v27, v14
v_cvt_pk_bf16_f32 v30, v24, v25
v_lshlrev_b32 v24, 16, v30
v_and_b32 v25, 0xffff0000, v30
v_cvt_pk_bf16_f32 v30, v26, v27
v_lshlrev_b32 v26, 16, v30
v_and_b32 v27, 0xffff0000, v30
v_lshlrev_b32 v31, 16, v54
v_add_f32 v20, v20, v31
v_and_b32 v31, 0xffff0000, v54
v_add_f32 v21, v21, v31
v_lshlrev_b32 v31, 16, v55
v_add_f32 v22, v22, v31
v_and_b32 v31, 0xffff0000, v55
v_add_f32 v23, v23, v31
v_cvt_pk_bf16_f32 v30, v20, v21
v_lshlrev_b32 v20, 16, v30
v_and_b32 v21, 0xffff0000, v30
v_cvt_pk_bf16_f32 v30, v22, v23
v_lshlrev_b32 v22, 16, v30
v_and_b32 v23, 0xffff0000, v30
v_add_f32 v24, v24, v20
v_add_f32 v25, v25, v21
v_add_f32 v26, v26, v22
v_add_f32 v27, v27, v23
v_cvt_pk_bf16_f32 v62, v24, v25
v_cvt_pk_bf16_f32 v63, v26, v27
s_mov_b32 s23, 24576
buffer_store_short v62, v17, s[32:35], s23 offen offset:0
buffer_store_short_d16_hi v62, v17, s[32:35], s23 offen offset:1024
buffer_store_short v63, v17, s[32:35], s23 offen offset:2048
buffer_store_short_d16_hi v63, v17, s[32:35], s23 offen offset:3072
fin_end:
s_endpgm
.section .rodata,"a"
.p2align 6
.amdhsa_kernel prep_kernel
  .amdhsa_next_free_vgpr 128
  .amdhsa_next_free_sgpr 102
  .amdhsa_accum_offset 128
  .amdhsa_group_segment_fixed_size 0
  .amdhsa_kernarg_size 136
  .amdhsa_user_sgpr_count 2
  .amdhsa_user_sgpr_kernarg_segment_ptr 1
  .amdhsa_system_sgpr_workgroup_id_x 1
.end_amdhsa_kernel
.p2align 6
.amdhsa_kernel mid_kernel
  .amdhsa_next_free_vgpr 152
  .amdhsa_next_free_sgpr 102
  .amdhsa_accum_offset 152
  .amdhsa_group_segment_fixed_size 0
  .amdhsa_kernarg_size 136
  .amdhsa_user_sgpr_count 2
  .amdhsa_user_sgpr_kernarg_segment_ptr 1
  .amdhsa_system_sgpr_workgroup_id_x 1
.end_amdhsa_kernel
.p2align 6
.amdhsa_kernel fin_kernel
  .amdhsa_next_free_vgpr 152
  .amdhsa_next_free_sgpr 102
  .amdhsa_accum_offset 152
  .amdhsa_group_segment_fixed_size 0
  .amdhsa_kernarg_size 136
  .amdhsa_user_sgpr_count 2
  .amdhsa_user_sgpr_kernarg_segment_ptr 1
  .amdhsa_system_sgpr_workgroup_id_x 1
.end_amdhsa_kernel
```
